```python
import torch

def _softmax(x, axis=-1):
    return torch.softmax(x, dim=axis)
def _gelu(x):
    return torch.nn.functional.gelu(x, approximate="tanh")
def _silu(x):
    return torch.nn.functional.silu(x)
def _sigmoid(x):
    return torch.sigmoid(x)
def _layernorm(x, axis=-1, eps=1e-5):
    m = x.mean(dim=axis, keepdim=True)
    v = x.var(dim=axis, keepdim=True, unbiased=False)
    return (x - m) / torch.sqrt(v + eps)
def _scatter_add(tgt, idx, src, axis=0):
    return tgt.clone().index_add_(axis, idx, src)
def _segment_sum(src, seg, n):
    out = torch.zeros((n,) + src.shape[1:], dtype=src.dtype)
    return out.index_add_(0, seg, src)
def _pad(x, pw):
    flat = tuple(v for pair in reversed(pw) for v in pair)
    return torch.nn.functional.pad(x, flat)

kernel_name = 'sequential_preLN__mha_block_cached__dense_activation_silu__decode'

def setup_inputs():

    _w = (lambda a: (lambda t: t.to(torch.bfloat16) if t.is_floating_point() else t)(torch.as_tensor(a)))
    def _A_setup():
        B, Sq, D = 4, 1, 448
        H, Sk, Dh = 16, 8192, 256
        return {
            "x": _w((lambda *s: torch.randn(*s, dtype=torch.bfloat16) * 0.05)(B, Sq, D)),
            "k_cache": _w((lambda *s: torch.randn(*s, dtype=torch.bfloat16) * 3.2)(B, H, Sk, Dh)),
            "v_cache": _w((lambda *s: torch.randn(*s, dtype=torch.bfloat16) * 0.8)(B, H, Sk, Dh)),
            "wq": _w((lambda *s: torch.randn(*s, dtype=torch.bfloat16) * 3.2)(D, H * Dh) * (D ** -0.5)),
            "wo": _w((lambda *s: torch.randn(*s, dtype=torch.bfloat16) * 0.8)(H * Dh, D) * ((H * Dh) ** -0.5)),
        }
    _A_in = _A_setup()

    def _B_setup():
        B, S, D, F = 4, 1, 448, 1792
        return {
            "x": _w((lambda *s: torch.randn(*s, dtype=torch.bfloat16) * 0.05)(B, S, D)),
            "w1": _w((lambda *s: torch.randn(*s, dtype=torch.bfloat16) * 3.2)(D, F) * (D ** -0.5)),
            "w2": _w((lambda *s: torch.randn(*s, dtype=torch.bfloat16) * 0.8)(F, D) * (F ** -0.5)),
        }
    _B_in = _B_setup()

    return {
        "A_x": _A_in["x"],
        "A_k_cache": _A_in["k_cache"],
        "A_v_cache": _A_in["v_cache"],
        "A_wq": _A_in["wq"],
        "A_wo": _A_in["wo"],
        "B_x": _B_in["x"],
        "B_w1": _B_in["w1"],
        "B_w2": _B_in["w2"],
    }

def reference(A_x, A_k_cache, A_v_cache, A_wq, A_wo, B_x, B_w1, B_w2):
    def _A_ref(x, k_cache, v_cache, wq, wo):
        B, Sq, D = x.shape
        H, Dh = 16, 256
        q = (lambda x, *d: x.permute(*d))((x @ wq).reshape(B, Sq, H, Dh), 0, 2, 1, 3)
        scores = torch.einsum("bhqd,bhkd->bhqk", q, k_cache) * (Dh ** -0.5)
        p = _softmax(scores, axis=-1)
        o = torch.einsum("bhqk,bhkd->bhqd", p, v_cache)
        return (lambda x, *d: x.permute(*d))(o, 0, 2, 1, 3).reshape(B, Sq, H * Dh) @ wo

    def _B_ref(x, w1, w2):
        h = torch.einsum("bsd,df->bsf", x, w1)
        h = _silu(h)
        out = torch.einsum("bsf,fd->bsd", h, w2)
        return out

    x = A_x
    h = x + _A_ref(_layernorm(x, axis=-1), A_k_cache, A_v_cache, A_wq, A_wo)
    h2 = h + _B_ref(_layernorm(h, axis=-1), B_w1, B_w2)
    return h2
```

```asm
; @launch grid=(256,1,1) block=(512,1,1) lds=149504
.amdgcn_target "amdgcn-amd-amdhsa--gfx950"
.text
.globl sequential_preLN__mha_block_cached__dense_activation_silu__decode_kernel
.p2align 8
.type sequential_preLN__mha_block_cached__dense_activation_silu__decode_kernel,@function
sequential_preLN__mha_block_cached__dense_activation_silu__decode_kernel:
  s_cmp_ge_u32 s2, 0x100
  s_cbranch_scc1 L_end
  s_load_dwordx16 s[16:31], s[0:1], 0
  s_load_dwordx4 s[32:35], s[0:1], 64
  s_load_dwordx2 s[36:37], s[0:1], 80
  v_lshrrev_b32 v16, 6, v0
  v_and_b32 v1, 63, v0
  v_readfirstlane_b32 s4, v16
  v_and_b32 v2, 15, v0
  v_lshrrev_b32 v3, 4, v1
  v_bfe_u32 v17, v1, 3, 1
  v_and_b32 v18, 7, v1
  v_lshlrev_b32 v17, 9, v17
  v_lshlrev_b32 v18, 4, v18
  v_lshl_add_u32 v4, v3, 7, v17
  v_add_u32 v4, v4, v18
  v_add_u32 v5, 0x4000, v4
  v_lshlrev_b32 v15, 4, v1
  v_lshlrev_b32 v6, 4, v1
  v_add_u32 v7, 0x4000, v6
  s_lshr_b32 s8, s2, 3
  s_and_b32 s10, s8, 7
  s_mul_i32 s9, s10, 11
  s_lshr_b32 s9, s9, 5
  s_mul_i32 s9, s9, 3
  s_sub_u32 s9, s10, s9
  s_add_u32 s9, s9, 1
  s_bfe_u32 s7, s2, 0x20001
  s_and_b32 s11, s7, s9
  s_bcnt1_i32_b32 s11, s11
  s_xor_b32 s11, s11, s2
  s_and_b32 s11, s11, 1
  s_lshl_b32 s3, s8, 1
  s_add_u32 s3, s3, s11
  s_lshr_b32 s5, s3, 4
  s_and_b32 s6, s3, 15
  s_lshl_b32 s9, s3, 22
  s_lshr_b32 s13, s2, 3
  s_and_b32 s12, s2, 7
  s_cmp_eq_u32 s12, 0
  s_cselect_b32 s13, s13, 0xff
  v_mov_b32 v18, 0
  v_mov_b32 v19, 0
  v_mov_b32 v214, 0x2480
  v_mov_b32 v20, 0
  v_mov_b32 v21, 0
  ds_write_b128 v214, v[18:21]
  s_cmp_lt_u32 s13, 28
  s_cselect_b32 s10, 16, 24
  v_mov_b32 v36, 0
  v_mov_b32 v37, s10
  v_mov_b32 v38, 0
  v_mov_b32 v39, 0
  ds_write_b128 v214, v[36:39] offset:16
  v_mov_b32 v40, -1
  v_mov_b32 v41, -1
  v_mov_b32 v42, -1
  v_mov_b32 v43, -1
  v_lshlrev_b32 v22, 4, v0
  ds_write_b128 v22, v[40:43] offset:9472
  s_waitcnt lgkmcnt(0)
  s_mov_b32 s0, s13
  s_barrier
  s_cmp_ge_u32 s4, 4
  s_cbranch_scc1 L_stream
  s_setprio 3
  s_mul_i32 s10, s4, 0x380
  s_add_u32 s56, s16, s10
  s_addc_u32 s57, s17, 0
  s_mov_b32 s58, 0x380
  s_mov_b32 s59, 0x20000
  s_mov_b32 s48, s22
  s_mov_b32 s49, s23
  s_mov_b32 s50, 0x380000
  s_mov_b32 s51, 0x20000
  buffer_load_dwordx4 v[84:87], v15, s[56:59], 0 offen
  v_lshrrev_b32 v17, 1, v1
  v_lshlrev_b32 v17, 13, v17
  v_and_b32 v18, 1, v1
  v_lshl_add_u32 v17, v18, 4, v17
  s_lshl_b32 s10, s7, 2
  s_add_u32 s10, s10, s5
  s_lshl_b32 s10, s10, 5
  s_lshl_b32 s11, s6, 9
  s_add_u32 s10, s10, s11
  s_lshl_b32 s11, s4, 18
  s_add_u32 s10, s10, s11
  s_lshl_b32 s11, s4, 10
  s_add_u32 s11, s11, 0x4600
  s_mov_b32 m0, s11
  s_nop 0
  buffer_load_dwordx4 v17, s[48:51], s10 offen nt lds
  s_add_u32 s10, s10, 0x100000
  s_add_u32 s11, s11, 0x1000
  s_mov_b32 m0, s11
  s_nop 0
  buffer_load_dwordx4 v17, s[48:51], s10 offen nt lds
  s_add_u32 s10, s10, 0x100000
  s_add_u32 s11, s11, 0x1000
  s_mov_b32 m0, s11
  s_nop 0
  buffer_load_dwordx4 v17, s[48:51], s10 offen nt lds
  s_add_u32 s10, s10, 0x100000
  s_add_u32 s11, s11, 0x1000
  s_mov_b32 m0, s11
  s_nop 0
  buffer_load_dwordx4 v17, s[48:51], s10 offen nt lds
  s_mov_b32 s76, s36
  s_mov_b32 s77, s37
  s_mov_b32 s78, 0x400000
  s_mov_b32 s79, 0x20000
  s_lshl_b32 s10, s4, 24
  v_mov_b32 v18, s10
  s_mov_b32 s10, 0x6000
  buffer_load_dword v224, v18, s[76:79], s10 offen sc1
  v_mov_b32 v116, -1
  v_mov_b32 v120, 0
  v_mov_b32 v117, -1
  v_mov_b32 v121, 0
  v_mov_b32 v118, -1
  v_mov_b32 v122, 0
  v_mov_b32 v119, -1
  v_mov_b32 v123, 0
  s_lshl_b32 s10, s3, 2
  s_add_u32 s10, s10, s7
  s_lshl_b32 s10, s10, 2
  s_add_u32 s10, s10, s4
  s_lshl_b32 s10, s10, 9
  s_add_u32 s10, s10, 0x80000
  v_mov_b32 v17, 0x1000000
  v_cmp_gt_u32 vcc, 17, v1
  s_nop 1
  v_cndmask_b32 v17, v17, v15, vcc
  buffer_store_dwordx4 v[116:119], v17, s[76:79], s10 offen sc1
  s_lshl_b32 s10, s3, 8
  s_add_u32 s10, s10, 0x60000
  s_xor_b32 s11, s4, 1
  s_add_u32 s11, s11, s7
  v_lshrrev_b32 v17, 1, v1
  v_add_u32 v17, s11, v17
  v_lshlrev_b32 v17, 24, v17
  v_lshl_add_u32 v17, v1, 7, v17
  buffer_store_dword v120, v17, s[76:79], s10 offen sc1
  s_lshl_b32 s10, s3, 2
  s_add_u32 s10, s10, s7
  s_lshl_b32 s10, s10, 13
  s_lshl_b32 s11, s4, 10
  s_add_u32 s10, s10, s11
  s_add_u32 s10, s10, 0x201000
  s_cmp_lt_u32 s0, 28
  s_cselect_b32 s11, 1, 2
  s_cmp_lt_u32 s4, s11
  s_cselect_b32 s10, 0x1000000, s10
  buffer_store_dwordx4 v[116:119], v15, s[76:79], s10 offen sc1
  s_mov_b32 s52, s24
  s_mov_b32 s53, s25
  s_mov_b32 s54, 0x380000
  s_mov_b32 s55, 0x20000
  s_mov_b32 s60, s28
  s_mov_b32 s61, s29
  s_mov_b32 s62, 0x188000
  s_mov_b32 s63, 0x20000
  s_mov_b32 s64, s30
  s_mov_b32 s65, s31
  s_mov_b32 s66, 0x188000
  s_mov_b32 s67, 0x20000
  s_mov_b32 s76, s36
  s_mov_b32 s77, s37
  s_mov_b32 s78, 0x400000
  s_mov_b32 s79, 0x20000
  s_mov_b32 s68, s32
  s_mov_b32 s69, s33
  s_mov_b32 s70, 0xe00
  s_mov_b32 s71, 0x20000
  s_mov_b32 s72, s34
  s_mov_b32 s73, s35
  s_mov_b32 s74, 0x100
  s_mov_b32 s75, 0x20000
  s_mov_b32 s100, s16
  s_mov_b32 s101, s17
  v_cmp_gt_u32_e64 s[92:93], 8, v2
  v_cmp_gt_u32_e64 s[94:95], 56, v1
  v_cmp_gt_u32_e64 s[96:97], 2, v3
  v_and_b32 v18, 1, v2
  v_lshlrev_b32 v18, 4, v18
  v_mov_b32 v19, 0xffff
  v_lshlrev_b32 v19, v18, v19
  v_bfe_u32 v18, v2, 1, 2
  v_cmp_eq_u32 vcc, 0, v18
  s_nop 1
  v_cndmask_b32 v8, 0, v19, vcc
  v_cmp_eq_u32 vcc, 1, v18
  s_nop 1
  v_cndmask_b32 v9, 0, v19, vcc
  v_cmp_eq_u32 vcc, 2, v18
  s_nop 1
  v_cndmask_b32 v10, 0, v19, vcc
  v_cmp_eq_u32 vcc, 3, v18
  s_nop 1
  v_cndmask_b32 v11, 0, v19, vcc
  v_mov_b32 v213, 1
  s_mov_b32 s83, 0x3db8aa3b
  v_lshrrev_b32 v220, 2, v1
  v_lshlrev_b32 v220, 14, v220
  v_and_b32 v22, 3, v1
  v_lshl_add_u32 v220, v22, 4, v220
  s_waitcnt vmcnt(8)
  v_lshlrev_b32 v148, 16, v84
  v_and_b32 v149, 0xffff0000, v84
  v_lshlrev_b32 v150, 16, v85
  v_and_b32 v151, 0xffff0000, v85
  v_lshlrev_b32 v152, 16, v86
  v_and_b32 v153, 0xffff0000, v86
  v_lshlrev_b32 v154, 16, v87
  v_and_b32 v155, 0xffff0000, v87
  v_add_f32 v16, v148, v149
  v_add_f32 v17, v150, v151
  v_add_f32 v18, v152, v153
  v_add_f32 v19, v154, v155
  v_add_f32 v16, v16, v17
  v_add_f32 v18, v18, v19
  v_add_f32 v16, v16, v18
  s_nop 1
  v_add_f32_dpp v16, v16, v16 quad_perm:[1,0,3,2] row_mask:0xf bank_mask:0xf
  s_nop 1
  v_add_f32_dpp v16, v16, v16 quad_perm:[2,3,0,1] row_mask:0xf bank_mask:0xf
  s_nop 1
  v_add_f32_dpp v16, v16, v16 row_half_mirror row_mask:0xf bank_mask:0xf
  s_nop 1
  v_add_f32_dpp v16, v16, v16 row_mirror row_mask:0xf bank_mask:0xf
  s_nop 1
  v_add_f32_dpp v16, v16, v16 row_bcast:15 row_mask:0xa bank_mask:0xf
  s_nop 1
  v_add_f32_dpp v16, v16, v16 row_bcast:31 row_mask:0xc bank_mask:0xf
  s_nop 0
  v_readlane_b32 s98, v16, 63
  s_nop 1
  v_mov_b32 v16, s98
  v_mul_f32 v16, 0x3b124925, v16
  v_sub_f32 v17, v148, v16
  v_mul_f32 v18, v17, v17
  v_sub_f32 v17, v149, v16
  v_fmac_f32 v18, v17, v17
  v_sub_f32 v17, v150, v16
  v_fmac_f32 v18, v17, v17
  v_sub_f32 v17, v151, v16
  v_fmac_f32 v18, v17, v17
  v_sub_f32 v17, v152, v16
  v_fmac_f32 v18, v17, v17
  v_sub_f32 v17, v153, v16
  v_fmac_f32 v18, v17, v17
  v_sub_f32 v17, v154, v16
  v_fmac_f32 v18, v17, v17
  v_sub_f32 v17, v155, v16
  v_fmac_f32 v18, v17, v17
  v_cndmask_b32 v18, 0, v18, s[94:95]
  s_nop 1
  v_add_f32_dpp v18, v18, v18 quad_perm:[1,0,3,2] row_mask:0xf bank_mask:0xf
  s_nop 1
  v_add_f32_dpp v18, v18, v18 quad_perm:[2,3,0,1] row_mask:0xf bank_mask:0xf
  s_nop 1
  v_add_f32_dpp v18, v18, v18 row_half_mirror row_mask:0xf bank_mask:0xf
  s_nop 1
  v_add_f32_dpp v18, v18, v18 row_mirror row_mask:0xf bank_mask:0xf
  s_nop 1
  v_add_f32_dpp v18, v18, v18 row_bcast:15 row_mask:0xa bank_mask:0xf
  s_nop 1
  v_add_f32_dpp v18, v18, v18 row_bcast:31 row_mask:0xc bank_mask:0xf
  s_nop 0
  v_readlane_b32 s99, v18, 63
  v_cvt_pk_bf16_f32 v16, v16, v16
  v_and_b32 v16, 0xffff0000, v16
  v_mov_b32 v18, s99
  v_mul_f32 v18, 0x3b124925, v18
  v_cvt_pk_bf16_f32 v18, v18, v18
  v_and_b32 v18, 0xffff0000, v18
  v_add_f32 v18, 0x3727c5ac, v18
  v_cvt_pk_bf16_f32 v18, v18, v18
  v_and_b32 v18, 0xffff0000, v18
  v_sqrt_f32 v18, v18
  s_nop 0
  v_cvt_pk_bf16_f32 v18, v18, v18
  v_and_b32 v18, 0xffff0000, v18
  v_rcp_f32 v18, v18
  v_sub_f32 v148, v148, v16
  v_sub_f32 v149, v149, v16
  v_cvt_pk_bf16_f32 v17, v148, v149
  v_lshlrev_b32 v148, 16, v17
  v_and_b32 v149, 0xffff0000, v17
  v_mul_f32 v148, v148, v18
  v_mul_f32 v149, v149, v18
  v_sub_f32 v150, v150, v16
  v_sub_f32 v151, v151, v16
  v_cvt_pk_bf16_f32 v17, v150, v151
  v_lshlrev_b32 v150, 16, v17
  v_and_b32 v151, 0xffff0000, v17
  v_mul_f32 v150, v150, v18
  v_mul_f32 v151, v151, v18
  v_sub_f32 v152, v152, v16
  v_sub_f32 v153, v153, v16
  v_cvt_pk_bf16_f32 v17, v152, v153
  v_lshlrev_b32 v152, 16, v17
  v_and_b32 v153, 0xffff0000, v17
  v_mul_f32 v152, v152, v18
  v_mul_f32 v153, v153, v18
  v_sub_f32 v154, v154, v16
  v_sub_f32 v155, v155, v16
  v_cvt_pk_bf16_f32 v17, v154, v155
  v_lshlrev_b32 v154, 16, v17
  v_and_b32 v155, 0xffff0000, v17
  v_mul_f32 v154, v154, v18
  v_mul_f32 v155, v155, v18
  v_cvt_pk_bf16_f32 v84, v148, v149
  v_cvt_pk_bf16_f32 v85, v150, v151
  v_cvt_pk_bf16_f32 v86, v152, v153
  v_cvt_pk_bf16_f32 v87, v154, v155
  s_mul_i32 s10, s4, 0x380
  v_add_u32 v16, s10, v15
  s_mov_b64 exec, s[94:95]
  ds_write_b128 v16, v[84:87]
  s_mov_b64 exec, 1
  s_waitcnt vmcnt(0) lgkmcnt(0)
  ds_add_u32 v214, v213 offset:8
  s_mov_b64 exec, -1
  s_cmp_lg_u32 s4, 0
  s_cbranch_scc1 L_svc_1
  v_and_b32 v22, 3, v1
  v_mul_u32_u24 v22, 0x380, v22
  v_lshl_add_u32 v22, v3, 4, v22
  v_bfe_u32 v20, v1, 2, 2
  v_lshl_add_u32 v20, v3, 3, v20
  v_lshlrev_b32 v20, 5, v20
  v_and_b32 v21, 3, v1
  v_lshl_add_u32 v20, v21, 3, v20
  s_mov_b32 s13, 0x186a00
  s_nop 0
L_sw_3:
  ds_read_b32 v16, v214 offset:8
  s_waitcnt lgkmcnt(0)
  v_readfirstlane_b32 s10, v16
  s_nop 0
  s_cmp_ge_u32 s10, 4
  s_nop 2
  s_cbranch_scc1 L_sok_4
  s_sub_u32 s13, s13, 1
  s_cmp_lg_u32 s13, 0
  s_cbranch_scc1 L_sw_3
L_sok_4:
  ds_read_b128 v[148:151], v22
  ds_read_b128 v[152:155], v22 offset:64
  ds_read_b128 v[156:159], v22 offset:128
  ds_read_b128 v[160:163], v22 offset:192
  ds_read_b128 v[164:167], v22 offset:256
  ds_read_b128 v[168:171], v22 offset:320
  ds_read_b128 v[172:175], v22 offset:384
  ds_read_b128 v[176:179], v22 offset:448
  ds_read_b128 v[180:183], v22 offset:512
  ds_read_b128 v[184:187], v22 offset:576
  ds_read_b128 v[188:191], v22 offset:640
  ds_read_b128 v[192:195], v22 offset:704
  ds_read_b128 v[196:199], v22 offset:768
  ds_read_b128 v[200:203], v22 offset:832
  ds_read_b64_tr_b16 v[84:85], v20 offset:17920
  ds_read_b64_tr_b16 v[86:87], v20 offset:18048
  ds_read_b64_tr_b16 v[88:89], v20 offset:18944
  ds_read_b64_tr_b16 v[90:91], v20 offset:19072
  ds_read_b64_tr_b16 v[92:93], v20 offset:19968
  ds_read_b64_tr_b16 v[94:95], v20 offset:20096
  ds_read_b64_tr_b16 v[96:97], v20 offset:20992
  ds_read_b64_tr_b16 v[98:99], v20 offset:21120
  ds_read_b64_tr_b16 v[100:101], v20 offset:22016
  ds_read_b64_tr_b16 v[102:103], v20 offset:22144
  ds_read_b64_tr_b16 v[104:105], v20 offset:23040
  ds_read_b64_tr_b16 v[106:107], v20 offset:23168
  ds_read_b64_tr_b16 v[108:109], v20 offset:24064
  ds_read_b64_tr_b16 v[110:111], v20 offset:24192
  ds_read_b64_tr_b16 v[112:113], v20 offset:25088
  ds_read_b64_tr_b16 v[114:115], v20 offset:25216
  ds_read_b64_tr_b16 v[116:117], v20 offset:26112
  ds_read_b64_tr_b16 v[118:119], v20 offset:26240
  ds_read_b64_tr_b16 v[120:121], v20 offset:27136
  ds_read_b64_tr_b16 v[122:123], v20 offset:27264
  ds_read_b64_tr_b16 v[124:125], v20 offset:28160
  ds_read_b64_tr_b16 v[126:127], v20 offset:28288
  ds_read_b64_tr_b16 v[128:129], v20 offset:29184
  ds_read_b64_tr_b16 v[130:131], v20 offset:29312
  ds_read_b64_tr_b16 v[132:133], v20 offset:30208
  ds_read_b64_tr_b16 v[134:135], v20 offset:30336
  ds_read_b64_tr_b16 v[136:137], v20 offset:31232
  ds_read_b64_tr_b16 v[138:139], v20 offset:31360
  v_add_u32 v224, 1, v224
  s_waitcnt lgkmcnt(15)
  v_mfma_f32_16x16x32_bf16 v[32:35], v[148:151], v[84:87], 0
  s_waitcnt lgkmcnt(15)
  v_mfma_f32_16x16x32_bf16 v[32:35], v[152:155], v[88:91], v[32:35]
  s_waitcnt lgkmcnt(15)
  v_mfma_f32_16x16x32_bf16 v[32:35], v[156:159], v[92:95], v[32:35]
  s_waitcnt lgkmcnt(15)
  v_mfma_f32_16x16x32_bf16 v[32:35], v[160:163], v[96:99], v[32:35]
  s_waitcnt lgkmcnt(15)
  v_mfma_f32_16x16x32_bf16 v[32:35], v[164:167], v[100:103], v[32:35]
  s_waitcnt lgkmcnt(15)
  v_mfma_f32_16x16x32_bf16 v[32:35], v[168:171], v[104:107], v[32:35]
  s_waitcnt lgkmcnt(14)
  v_mfma_f32_16x16x32_bf16 v[32:35], v[172:175], v[108:111], v[32:35]
  s_waitcnt lgkmcnt(12)
  v_mfma_f32_16x16x32_bf16 v[32:35], v[176:179], v[112:115], v[32:35]
  s_waitcnt lgkmcnt(10)
  v_mfma_f32_16x16x32_bf16 v[32:35], v[180:183], v[116:119], v[32:35]
  s_waitcnt lgkmcnt(8)
  v_mfma_f32_16x16x32_bf16 v[32:35], v[184:187], v[120:123], v[32:35]
  s_waitcnt lgkmcnt(6)
  v_mfma_f32_16x16x32_bf16 v[32:35], v[188:191], v[124:127], v[32:35]
  s_waitcnt lgkmcnt(4)
  v_mfma_f32_16x16x32_bf16 v[32:35], v[192:195], v[128:131], v[32:35]
  s_waitcnt lgkmcnt(2)
  v_mfma_f32_16x16x32_bf16 v[32:35], v[196:199], v[132:135], v[32:35]
  s_waitcnt lgkmcnt(0)
  v_mfma_f32_16x16x32_bf16 v[32:35], v[200:203], v[136:139], v[32:35]
  v_lshlrev_b32 v20, 10, v3
  v_lshl_add_u32 v20, v2, 2, v20
  v_and_b32 v21, 1, v2
  v_lshl_add_u32 v20, v21, 24, v20
  s_lshl_b32 s10, s7, 2
  s_add_u32 s10, s10, s5
  s_lshl_b32 s10, s10, 6
  s_lshl_b32 s11, s6, 12
  s_add_u32 s10, s10, s11
  s_add_u32 s10, s10, 0x40000
  v_cmp_eq_u32 vcc, 1, v3
  s_nop 1
  v_cndmask_b32 v32, v32, v33, vcc
  v_cmp_eq_u32 vcc, 2, v3
  s_nop 1
  v_cndmask_b32 v32, v32, v34, vcc
  v_cmp_eq_u32 vcc, 3, v3
  s_nop 1
  v_cndmask_b32 v32, v32, v35, vcc
  s_nop 1
  v_mov_b32_dpp v33, v32 quad_perm:[1,0,3,2] row_mask:0xf bank_mask:0xf
  v_cvt_pk_bf16_f32 v36, v32, v33
  v_mov_b32 v37, v224
  buffer_store_dwordx2 v[36:37], v20, s[76:79], s10 offen sc1
  s_lshl_b32 s12, s5, 10
  s_add_u32 s12, s12, s11
  s_add_u32 s12, s12, 0x40000
  v_readfirstlane_b32 s32, v224
  s_mov_b32 s13, 0x30d40
  s_nop 3
L_spin_6:
  buffer_load_dwordx4 v[40:43], v15, s[76:79], s12 offen sc1
  s_waitcnt vmcnt(0)
  v_cmp_ne_u32_e64 s[10:11], s32, v41
  v_cmp_ne_u32 vcc, s32, v43
  s_nop 0
  s_or_b64 s[10:11], s[10:11], vcc
  s_cmp_eq_u64 s[10:11], 0
  s_nop 1
  s_cbranch_scc1 L_done_5
  s_sleep 2
  s_sub_u32 s13, s13, 1
  s_cmp_lg_u32 s13, 0
  s_cbranch_scc1 L_spin_6
L_done_5:
  v_mov_b32 v41, v42
  v_lshlrev_b32 v20, 3, v1
  ds_write_b64 v20, v[40:41] offset:8704
  s_waitcnt lgkmcnt(0)
  ds_write_b32 v214, v213 offset:4
  s_branch L_svc2_2
L_svc_1:
  s_cmp_ge_u32 s0, 28
  s_cbranch_scc1 L_nodma_7
  s_sub_u32 s10, s4, 1
L_ini_8:
  s_lshl_b32 s11, s10, 10
  s_lshl_b32 s12, s0, 14
  s_add_u32 s12, s12, 0x100000
  s_mul_i32 s13, s0, 0x1c00
  s_add_u32 s13, s13, 0x4000
  s_cmp_lt_u32 s10, 16
  s_cselect_b32 s12, s12, s13
  s_add_u32 s12, s12, s11
  buffer_store_dwordx4 v[116:119], v15, s[76:79], s12 offen sc1
  s_add_u32 s10, s10, 3
  s_cmp_lt_u32 s10, 23
  s_cbranch_scc1 L_ini_8
  v_and_b32 v18, 3, v2
  v_mul_u32_u24 v17, 0x380, v3
  v_lshl_add_u32 v17, v18, 4, v17
  v_lshrrev_b32 v18, 2, v2
  v_lshl_add_u32 v17, v18, 1, v17
  v_bfe_u32 v18, v2, 2, 1
  v_lshl_add_u32 v17, v18, 24, v17
  s_lshr_b32 s12, s0, 1
  s_lshl_b32 s12, s12, 6
  s_and_b32 s11, s0, 1
  s_lshl_b32 s11, s11, 3
  s_add_u32 s12, s12, s11
  buffer_store_dword v116, v17, s[76:79], s12 offen sc1
  s_mov_b64 exec, 1
  s_waitcnt vmcnt(0)
  ds_add_rtn_u32 v212, v214, v213 offset:12
  s_waitcnt lgkmcnt(0)
  s_mov_b64 exec, -1
  v_readfirstlane_b32 s10, v212
  s_nop 0
  s_cmp_lg_u32 s10, 2
  s_nop 2
  s_cbranch_scc1 L_nosig_9
  s_getreg_b32 s98, hwreg(HW_REG_XCC_ID)
  s_and_b32 s98, s98, 15
  s_mul_i32 s99, s98, s98
  s_lshl_b32 s98, s98, 8
  s_lshl_b32 s99, s99, 18
  s_or_b32 s8, s98, s99
  s_or_b32 s8, s8, 1
  s_atomic_add s8, s[34:35], 40
L_nosig_9:
  v_lshrrev_b32 v22, 3, v1
  v_mul_u32_u24 v22, 0xe00, v22
  v_and_b32 v23, 7, v1
  v_lshl_add_u32 v22, v23, 4, v22
  s_sub_u32 s10, s4, 1
  s_nop 0
L_dma_10:
  s_lshl_b32 s11, s10, 10
  s_mul_i32 s12, s10, 0x7000
  s_lshl_b32 s13, s0, 7
  s_add_u32 s12, s12, s13
  s_mul_i32 s13, s0, 0xe000
  s_add_u32 s13, s13, s11
  s_add_u32 s8, s11, 0x8800
  s_mov_b32 m0, s8
  s_nop 0
  buffer_load_dwordx4 v22, s[60:63], s12 offen nt lds
  s_add_u32 s8, s11, 0x16800
  s_mov_b32 m0, s8
  s_nop 0
  buffer_load_dwordx4 v15, s[64:67], s13 offen nt lds
  s_add_u32 s10, s10, 3
  s_cmp_lt_u32 s10, 56
  s_cbranch_scc1 L_dma_10
L_nodma_7:
L_svc2_2:
  v_mul_u32_u24 v12, 0x380, v3
  v_lshl_add_u32 v12, v2, 4, v12
  v_and_b32 v18, 7, v2
  v_lshlrev_b32 v19, 4, v18
  v_lshrrev_b32 v20, 3, v2
  v_mul_u32_u24 v21, 0xe00, v20
  v_mul_u32_u24 v13, 0x380, v3
  v_add3_u32 v13, v13, v19, v21
  v_add_u32 v13, 0x300, v13
  s_lshl_b32 s10, s6, 8
  s_lshl_b32 s11, s7, 6
  s_add_u32 s10, s10, s11
  s_lshl_b32 s11, s4, 4
  s_add_u32 s10, s10, s11
  s_mul_i32 s10, s10, 0x380
  buffer_load_dwordx4 v[148:151], v12, s[52:55], s10 offen nt
  buffer_load_dwordx4 v[152:155], v12, s[52:55], s10 offen offset:256 nt
  buffer_load_dwordx4 v[156:159], v12, s[52:55], s10 offen offset:512 nt
  buffer_load_dwordx4 v[196:199], v13, s[52:55], s10 offen nt
  s_add_u32 s10, s10, 0xe00
  buffer_load_dwordx4 v[160:163], v12, s[52:55], s10 offen nt
  buffer_load_dwordx4 v[164:167], v12, s[52:55], s10 offen offset:256 nt
  buffer_load_dwordx4 v[168:171], v12, s[52:55], s10 offen offset:512 nt
  s_add_u32 s10, s10, 0xe00
  buffer_load_dwordx4 v[172:175], v12, s[52:55], s10 offen nt
  buffer_load_dwordx4 v[176:179], v12, s[52:55], s10 offen offset:256 nt
  buffer_load_dwordx4 v[180:183], v12, s[52:55], s10 offen offset:512 nt
  buffer_load_dwordx4 v[200:203], v13, s[52:55], s10 offen nt
  s_add_u32 s10, s10, 0xe00
  buffer_load_dwordx4 v[184:187], v12, s[52:55], s10 offen nt
  buffer_load_dwordx4 v[188:191], v12, s[52:55], s10 offen offset:256 nt
  buffer_load_dwordx4 v[192:195], v12, s[52:55], s10 offen offset:512 nt
  v_lshl_add_u32 v21, v20, 2, v3
  v_lshlrev_b32 v21, 7, v21
  v_lshl_add_u32 v219, v18, 4, v21
  s_lshl_b32 s10, s4, 11
  v_add_u32 v219, s10, v219
  v_and_b32 v22, 3, v2
  v_lshrrev_b32 v23, 2, v2
  v_mul_u32_u24 v217, 0x410, v22
  v_lshl_add_u32 v217, v3, 6, v217
  v_lshl_add_u32 v217, v23, 4, v217
  s_lshl_b32 s10, s4, 8
  v_add_u32 v217, s10, v217
  v_lshlrev_b32 v218, 3, v22
  v_lshlrev_b32 v221, 6, v3
  v_lshl_add_u32 v221, v23, 4, v221
  v_lshl_add_u32 v221, v22, 24, v221
  v_mov_b32 v18, 0x100
  v_cmp_eq_u32_e64 s[84:85], 1, v1
  s_nop 1
  v_cndmask_b32 v221, v221, v18, s[84:85]
  s_lshl_b32 s10, s7, 9
  v_lshlrev_b32 v223, 11, v22
  v_add_u32 v223, s10, v223
  s_lshr_b32 s11, s4, 1
  s_lshl_b32 s11, s11, 5
  s_and_b32 s10, s4, 1
  s_lshl_b32 s10, s10, 1
  s_add_u32 s11, s11, s10
  v_lshlrev_b32 v18, 3, v3
  v_and_b32 v19, 1, v23
  v_lshl_add_u32 v18, v19, 2, v18
  v_lshrrev_b32 v19, 1, v23
  v_add3_u32 v18, v18, v19, s11
  v_lshl_add_u32 v222, v18, 2, v223
  s_cmp_lg_u32 s4, 1
  s_nop 0
  s_cbranch_scc1 L_nochk_11
  s_mov_b32 s13, 0x30d40
L_mw_12:
  ds_read_b32 v16, v214
  s_waitcnt lgkmcnt(0)
  v_readfirstlane_b32 s10, v16
  s_nop 0
  s_cmp_ge_u32 s10, 4
  s_nop 2
  s_cbranch_scc1 L_mok_13
  s_sleep 64
  s_sub_u32 s13, s13, 1
  s_cmp_lg_u32 s13, 0
  s_cbranch_scc1 L_mw_12
L_mok_13:
  s_mov_b32 s13, 0x30d40
L_spin_15:
  v_mov_b32 v23, 0
  buffer_load_dword v215, v23, s[72:75], 0 offen offset:40 sc1
  s_waitcnt vmcnt(0)
  v_readfirstlane_b32 s10, v215
  s_nop 0
  s_and_b32 s11, s10, 0xff
  s_cmp_ge_u32 s11, 28
  s_nop 1
  s_cbranch_scc1 L_done_14
  s_sleep 64
  s_sub_u32 s13, s13, 1
  s_cmp_lg_u32 s13, 0
  s_cbranch_scc1 L_spin_15
L_done_14:
  s_getreg_b32 s98, hwreg(HW_REG_XCC_ID)
  s_and_b32 s98, s98, 15
  s_mul_i32 s99, s98, s98
  s_lshl_b32 s98, s98, 8
  s_lshl_b32 s99, s99, 18
  s_or_b32 s11, s98, s99
  s_or_b32 s11, s11, 1
  s_mul_i32 s11, s11, 28
  s_cmp_eq_u32 s10, s11
  s_cselect_b32 s10, 1, 0
  v_mov_b32 v23, s10
  ds_write_b32 v214, v23 offset:16
  s_nop 0
L_nochk_11:
  s_waitcnt vmcnt(0) lgkmcnt(0)
  s_lshl_b32 s12, s3, 13
  s_add_u32 s12, s12, 0x80000
  s_lshl_b32 s10, s7, 2
  s_add_u32 s10, s10, s4
  s_lshl_b32 s10, s10, 9
  s_add_u32 s11, s12, s10
  s_barrier
  ds_read_b64 v[40:41], v218 offset:9216
  ds_read_b128 v[36:39], v217 offset:26112
  v_and_b32 v21, 3, v2
  s_waitcnt lgkmcnt(1)
  v_mov_b32 v16, v40
  s_nop 1
  v_max_f32_dpp v16, v16, v16 quad_perm:[1,0,3,2] row_mask:0xf bank_mask:0xf
  s_nop 1
  v_max_f32_dpp v16, v16, v16 quad_perm:[2,3,0,1] row_mask:0xf bank_mask:0xf
  v_sub_f32 v18, v40, v16
  v_mul_f32 v18, s83, v18
  v_exp_f32 v18, v18
  s_waitcnt lgkmcnt(0)
  v_mul_f32 v17, v41, v18
  v_mul_f32 v36, v36, v18
  v_mul_f32 v37, v37, v18
  v_mul_f32 v38, v38, v18
  v_mul_f32 v39, v39, v18
  v_add_f32_dpp v36, v36, v36 quad_perm:[1,0,3,2] row_mask:0xf bank_mask:0xf
  v_add_f32_dpp v37, v37, v37 quad_perm:[1,0,3,2] row_mask:0xf bank_mask:0xf
  v_add_f32_dpp v38, v38, v38 quad_perm:[1,0,3,2] row_mask:0xf bank_mask:0xf
  v_add_f32_dpp v39, v39, v39 quad_perm:[1,0,3,2] row_mask:0xf bank_mask:0xf
  v_add_f32_dpp v17, v17, v17 quad_perm:[1,0,3,2] row_mask:0xf bank_mask:0xf
  v_add_f32_dpp v36, v36, v36 quad_perm:[2,3,0,1] row_mask:0xf bank_mask:0xf
  v_add_f32_dpp v37, v37, v37 quad_perm:[2,3,0,1] row_mask:0xf bank_mask:0xf
  v_add_f32_dpp v38, v38, v38 quad_perm:[2,3,0,1] row_mask:0xf bank_mask:0xf
  v_add_f32_dpp v39, v39, v39 quad_perm:[2,3,0,1] row_mask:0xf bank_mask:0xf
  v_add_f32_dpp v17, v17, v17 quad_perm:[2,3,0,1] row_mask:0xf bank_mask:0xf
  v_cndmask_b32 v36, v36, v16, s[84:85]
  v_cndmask_b32 v37, v37, v17, s[84:85]
  v_min_u32 v36, -2, v36
  v_min_u32 v37, -2, v37
  v_min_u32 v38, -2, v38
  v_min_u32 v39, -2, v39
  buffer_store_dwordx4 v[36:39], v221, s[76:79], s11 offen sc1
  s_mov_b32 s13, 0x30d40
  s_nop 0
L_spin_17:
  buffer_load_dword v44, v222, s[76:79], s12 offen sc1
  buffer_load_dwordx2 v[46:47], v223, s[76:79], s12 offen offset:256 sc1
  s_waitcnt vmcnt(0)
  v_max3_u32 v18, v44, v46, v47
  v_cmp_eq_u32_e64 s[10:11], -1, v18
  s_nop 0
  s_cmp_eq_u64 s[10:11], 0
  s_nop 2
  s_cbranch_scc1 L_done_16
  s_sub_u32 s13, s13, 1
  s_cmp_lg_u32 s13, 0
  s_cbranch_scc1 L_spin_17
L_done_16:
  v_mov_b32 v16, v46
  s_nop 1
  v_max_f32_dpp v16, v16, v16 quad_perm:[1,0,3,2] row_mask:0xf bank_mask:0xf
  s_nop 1
  v_max_f32_dpp v16, v16, v16 quad_perm:[2,3,0,1] row_mask:0xf bank_mask:0xf
  v_sub_f32 v17, v46, v16
  v_mul_f32 v17, s83, v17
  v_exp_f32 v17, v17
  s_nop 0
  v_mul_f32 v44, v44, v17
  v_mul_f32 v47, v47, v17
  s_nop 0
  v_add_f32_dpp v44, v44, v44 quad_perm:[1,0,3,2] row_mask:0xf bank_mask:0xf
  v_add_f32_dpp v47, v47, v47 quad_perm:[1,0,3,2] row_mask:0xf bank_mask:0xf
  s_nop 0
  v_add_f32_dpp v44, v44, v44 quad_perm:[2,3,0,1] row_mask:0xf bank_mask:0xf
  v_add_f32_dpp v47, v47, v47 quad_perm:[2,3,0,1] row_mask:0xf bank_mask:0xf
  v_rcp_f32 v47, v47
  s_nop 0
  v_mul_f32 v44, v44, v47
  v_cvt_pk_bf16_f32 v44, v44, v44
  s_nop 1
  v_and_b32_dpp v52, v44, v8 row_newbcast:0 row_mask:0xf bank_mask:0xf
  v_and_b32_dpp v53, v44, v9 row_newbcast:0 row_mask:0xf bank_mask:0xf
  v_and_b32_dpp v54, v44, v10 row_newbcast:0 row_mask:0xf bank_mask:0xf
  v_and_b32_dpp v55, v44, v11 row_newbcast:0 row_mask:0xf bank_mask:0xf
  s_nop 1
  v_mfma_f32_16x16x32_bf16 v[84:87], v[148:151], v[52:55], 0
  v_mfma_f32_16x16x32_bf16 v[88:91], v[152:155], v[52:55], 0
  v_mfma_f32_16x16x32_bf16 v[92:95], v[156:159], v[52:55], 0
  v_mfma_f32_16x16x32_bf16 v[96:99], v[196:199], v[52:55], 0
  v_and_b32_dpp v56, v44, v8 row_newbcast:4 row_mask:0xf bank_mask:0xf
  v_and_b32_dpp v57, v44, v9 row_newbcast:4 row_mask:0xf bank_mask:0xf
  v_and_b32_dpp v58, v44, v10 row_newbcast:4 row_mask:0xf bank_mask:0xf
  v_and_b32_dpp v59, v44, v11 row_newbcast:4 row_mask:0xf bank_mask:0xf
  s_nop 1
  v_mfma_f32_16x16x32_bf16 v[84:87], v[160:163], v[56:59], v[84:87]
  v_mfma_f32_16x16x32_bf16 v[88:91], v[164:167], v[56:59], v[88:91]
  v_mfma_f32_16x16x32_bf16 v[92:95], v[168:171], v[56:59], v[92:95]
  v_mfma_f32_16x16x32_bf16 v[100:103], v[196:199], v[56:59], 0
  v_and_b32_dpp v60, v44, v8 row_newbcast:8 row_mask:0xf bank_mask:0xf
  v_and_b32_dpp v61, v44, v9 row_newbcast:8 row_mask:0xf bank_mask:0xf
  v_and_b32_dpp v62, v44, v10 row_newbcast:8 row_mask:0xf bank_mask:0xf
  v_and_b32_dpp v63, v44, v11 row_newbcast:8 row_mask:0xf bank_mask:0xf
  s_nop 1
  v_mfma_f32_16x16x32_bf16 v[84:87], v[172:175], v[60:63], v[84:87]
  v_mfma_f32_16x16x32_bf16 v[88:91], v[176:179], v[60:63], v[88:91]
  v_mfma_f32_16x16x32_bf16 v[92:95], v[180:183], v[60:63], v[92:95]
  v_mfma_f32_16x16x32_bf16 v[96:99], v[200:203], v[60:63], v[96:99]
  v_and_b32_dpp v64, v44, v8 row_newbcast:12 row_mask:0xf bank_mask:0xf
  v_and_b32_dpp v65, v44, v9 row_newbcast:12 row_mask:0xf bank_mask:0xf
  v_and_b32_dpp v66, v44, v10 row_newbcast:12 row_mask:0xf bank_mask:0xf
  v_and_b32_dpp v67, v44, v11 row_newbcast:12 row_mask:0xf bank_mask:0xf
  s_nop 1
  v_mfma_f32_16x16x32_bf16 v[84:87], v[184:187], v[64:67], v[84:87]
  v_mfma_f32_16x16x32_bf16 v[88:91], v[188:191], v[64:67], v[88:91]
  v_mfma_f32_16x16x32_bf16 v[92:95], v[192:195], v[64:67], v[92:95]
  v_mfma_f32_16x16x32_bf16 v[100:103], v[200:203], v[64:67], v[100:103]
  s_nop 5
  v_cndmask_b32 v84, v88, v84, s[92:93]
  v_cndmask_b32 v85, v89, v85, s[92:93]
  v_cndmask_b32 v86, v90, v86, s[92:93]
  v_cndmask_b32 v87, v91, v87, s[92:93]
  ds_write_b128 v219, v[84:87] offset:17920
  v_cndmask_b32 v96, v100, v96, s[96:97]
  v_cndmask_b32 v92, v96, v92, s[92:93]
  v_cndmask_b32 v97, v101, v97, s[96:97]
  v_cndmask_b32 v93, v97, v93, s[92:93]
  v_cndmask_b32 v98, v102, v98, s[96:97]
  v_cndmask_b32 v94, v98, v94, s[92:93]
  v_cndmask_b32 v99, v103, v99, s[96:97]
  v_cndmask_b32 v95, v99, v95, s[92:93]
  ds_write_b128 v219, v[92:95] offset:18944
  s_nop 0
  s_branch L_b4
L_stream:
  s_setprio 2
  s_add_u32 s40, s18, s9
  s_addc_u32 s41, s19, 0
  s_mov_b32 s42, 0x400000
  s_mov_b32 s43, 0x20000
  s_add_u32 s44, s20, s9
  s_addc_u32 s45, s21, 0
  s_mov_b32 s46, 0x400000
  s_mov_b32 s47, 0x20000
  s_lshl_b32 s28, s7, 8
  s_add_u32 s28, s28, s4
  s_sub_u32 s28, s28, 4
  s_lshl_b32 s28, s28, 12
  s_mov_b32 s13, s28
  buffer_load_dwordx4 v[148:151], v4, s[40:43], s28 offen nt
  buffer_load_dwordx4 v[152:155], v4, s[40:43], s28 offen offset:1024 nt
  buffer_load_dwordx4 v[156:159], v4, s[40:43], s28 offen offset:2048 nt
  buffer_load_dwordx4 v[160:163], v4, s[40:43], s28 offen offset:3072 nt
  buffer_load_dwordx4 v[164:167], v5, s[40:43], s28 offen nt
  buffer_load_dwordx4 v[168:171], v5, s[40:43], s28 offen offset:1024 nt
  buffer_load_dwordx4 v[172:175], v5, s[40:43], s28 offen offset:2048 nt
  buffer_load_dwordx4 v[176:179], v5, s[40:43], s28 offen offset:3072 nt
  s_add_u32 s28, s28, 0x8000
  buffer_load_dwordx4 v[180:183], v4, s[40:43], s28 offen nt
  buffer_load_dwordx4 v[184:187], v4, s[40:43], s28 offen offset:1024 nt
  buffer_load_dwordx4 v[188:191], v4, s[40:43], s28 offen offset:2048 nt
  buffer_load_dwordx4 v[192:195], v4, s[40:43], s28 offen offset:3072 nt
  buffer_load_dwordx4 v[196:199], v5, s[40:43], s28 offen nt
  buffer_load_dwordx4 v[200:203], v5, s[40:43], s28 offen offset:1024 nt
  buffer_load_dwordx4 v[204:207], v5, s[40:43], s28 offen offset:2048 nt
  buffer_load_dwordx4 v[208:211], v5, s[40:43], s28 offen offset:3072 nt
  s_add_u32 s28, s28, 0x8000
  s_mov_b32 s29, 2
  s_cmp_lt_u32 s0, 28
  s_cbranch_scc1 L_cd_18
  s_mov_b32 s29, 4
  s_sub_u32 s12, s4, 4
  s_lshl_b32 s12, s12, 14
  s_add_u32 s12, s12, 0x8800
  s_add_u32 s8, s12, 0
  s_mov_b32 m0, s8
  s_nop 0
  buffer_load_dwordx4 v4, s[40:43], s28 offen nt lds
  s_add_u32 s8, s12, 0
  s_mov_b32 m0, s8
  s_nop 0
  buffer_load_dwordx4 v4, s[40:43], s28 offen offset:1024 nt lds
  s_add_u32 s8, s12, 0
  s_mov_b32 m0, s8
  s_nop 0
  buffer_load_dwordx4 v4, s[40:43], s28 offen offset:2048 nt lds
  s_add_u32 s8, s12, 0
  s_mov_b32 m0, s8
  s_nop 0
  buffer_load_dwordx4 v4, s[40:43], s28 offen offset:3072 nt lds
  s_add_u32 s8, s12, 0x1000
  s_mov_b32 m0, s8
  s_nop 0
  buffer_load_dwordx4 v5, s[40:43], s28 offen nt lds
  s_add_u32 s8, s12, 0x1000
  s_mov_b32 m0, s8
  s_nop 0
  buffer_load_dwordx4 v5, s[40:43], s28 offen offset:1024 nt lds
  s_add_u32 s8, s12, 0x1000
  s_mov_b32 m0, s8
  s_nop 0
  buffer_load_dwordx4 v5, s[40:43], s28 offen offset:2048 nt lds
  s_add_u32 s8, s12, 0x1000
  s_mov_b32 m0, s8
  s_nop 0
  buffer_load_dwordx4 v5, s[40:43], s28 offen offset:3072 nt lds
  s_add_u32 s28, s28, 0x8000
  s_add_u32 s8, s12, 0x2000
  s_mov_b32 m0, s8
  s_nop 0
  buffer_load_dwordx4 v4, s[40:43], s28 offen nt lds
  s_add_u32 s8, s12, 0x2000
  s_mov_b32 m0, s8
  s_nop 0
  buffer_load_dwordx4 v4, s[40:43], s28 offen offset:1024 nt lds
  s_add_u32 s8, s12, 0x2000
  s_mov_b32 m0, s8
  s_nop 0
  buffer_load_dwordx4 v4, s[40:43], s28 offen offset:2048 nt lds
  s_add_u32 s8, s12, 0x2000
  s_mov_b32 m0, s8
  s_nop 0
  buffer_load_dwordx4 v4, s[40:43], s28 offen offset:3072 nt lds
  s_add_u32 s8, s12, 0x3000
  s_mov_b32 m0, s8
  s_nop 0
  buffer_load_dwordx4 v5, s[40:43], s28 offen nt lds
  s_add_u32 s8, s12, 0x3000
  s_mov_b32 m0, s8
  s_nop 0
  buffer_load_dwordx4 v5, s[40:43], s28 offen offset:1024 nt lds
  s_add_u32 s8, s12, 0x3000
  s_mov_b32 m0, s8
  s_nop 0
  buffer_load_dwordx4 v5, s[40:43], s28 offen offset:2048 nt lds
  s_add_u32 s8, s12, 0x3000
  s_mov_b32 m0, s8
  s_nop 0
  buffer_load_dwordx4 v5, s[40:43], s28 offen offset:3072 nt lds
  s_add_u32 s28, s28, 0x8000
L_cd_18:
  buffer_load_dwordx4 v[84:87], v4, s[40:43], s28 offen nt
  buffer_load_dwordx4 v[88:91], v4, s[40:43], s28 offen offset:1024 nt
  buffer_load_dwordx4 v[92:95], v4, s[40:43], s28 offen offset:2048 nt
  buffer_load_dwordx4 v[96:99], v4, s[40:43], s28 offen offset:3072 nt
  buffer_load_dwordx4 v[100:103], v5, s[40:43], s28 offen nt
  buffer_load_dwordx4 v[104:107], v5, s[40:43], s28 offen offset:1024 nt
  buffer_load_dwordx4 v[108:111], v5, s[40:43], s28 offen offset:2048 nt
  buffer_load_dwordx4 v[112:115], v5, s[40:43], s28 offen offset:3072 nt
  s_add_u32 s11, s28, 0x8000
  buffer_load_dwordx4 v[116:119], v4, s[40:43], s11 offen nt
  buffer_load_dwordx4 v[120:123], v4, s[40:43], s11 offen offset:1024 nt
  buffer_load_dwordx4 v[124:127], v4, s[40:43], s11 offen offset:2048 nt
  buffer_load_dwordx4 v[128:131], v4, s[40:43], s11 offen offset:3072 nt
  buffer_load_dwordx4 v[132:135], v5, s[40:43], s11 offen nt
  buffer_load_dwordx4 v[136:139], v5, s[40:43], s11 offen offset:1024 nt
  buffer_load_dwordx4 v[140:143], v5, s[40:43], s11 offen offset:2048 nt
  buffer_load_dwordx4 v[144:147], v5, s[40:43], s11 offen offset:3072 nt
  s_mov_b32 s76, s36
  s_mov_b32 s77, s37
  s_mov_b32 s78, 0x400000
  s_mov_b32 s79, 0x20000
  s_mov_b32 s68, s32
  s_mov_b32 s69, s33
  s_mov_b32 s70, 0xe00
  s_mov_b32 s71, 0x20000
  s_mov_b32 s72, s34
  s_mov_b32 s73, s35
  s_mov_b32 s74, 0x100
  s_mov_b32 s75, 0x20000
  s_mov_b32 s100, s16
  s_mov_b32 s101, s17
  v_cmp_gt_u32_e64 s[92:93], 8, v2
  v_cmp_gt_u32_e64 s[94:95], 56, v1
  v_cmp_gt_u32_e64 s[96:97], 2, v3
  v_and_b32 v18, 1, v2
  v_lshlrev_b32 v18, 4, v18
  v_mov_b32 v19, 0xffff
  v_lshlrev_b32 v19, v18, v19
  v_bfe_u32 v18, v2, 1, 2
  v_cmp_eq_u32 vcc, 0, v18
  s_nop 1
  v_cndmask_b32 v8, 0, v19, vcc
  v_cmp_eq_u32 vcc, 1, v18
  s_nop 1
  v_cndmask_b32 v9, 0, v19, vcc
  v_cmp_eq_u32 vcc, 2, v18
  s_nop 1
  v_cndmask_b32 v10, 0, v19, vcc
  v_cmp_eq_u32 vcc, 3, v18
  s_nop 1
  v_cndmask_b32 v11, 0, v19, vcc
  v_mov_b32 v213, 1
  s_mov_b32 s83, 0x3db8aa3b
  v_lshrrev_b32 v220, 2, v1
  v_lshlrev_b32 v220, 14, v220
  v_and_b32 v22, 3, v1
  v_lshl_add_u32 v220, v22, 4, v220
  s_lshl_b32 s10, s3, 8
  s_add_u32 s10, s10, 0x60000
  s_add_u32 s80, s36, s10
  s_addc_u32 s81, s37, 0
  v_lshrrev_b32 v18, 2, v2
  v_xor_b32 v18, v18, v3
  v_and_b32 v18, 1, v18
  v_cmp_eq_u32_e64 s[84:85], 0, v18
  v_lshrrev_b32 v18, 3, v2
  v_xor_b32 v18, v18, v3
  v_and_b32 v18, 1, v18
  v_cmp_eq_u32_e64 s[86:87], 0, v18
  s_nop 1
  v_cndmask_b32 v8, 0, v8, s[86:87]
  v_cndmask_b32 v9, 0, v9, s[86:87]
  v_cndmask_b32 v10, 0, v10, s[86:87]
  v_cndmask_b32 v11, 0, v11, s[86:87]
  v_mov_b32 v24, 0
  v_mov_b32 v25, 0
  v_mov_b32 v26, 0
  v_mov_b32 v27, 0
  v_mov_b32 v14, 0
  s_mov_b32 s38, 0xff61b1e6
  s_mov_b32 s82, 0
  v_lshrrev_b32 v20, 3, v2
  v_lshl_add_u32 v21, v20, 2, v3
  v_lshlrev_b32 v21, 7, v21
  v_and_b32 v22, 3, v2
  v_lshl_add_u32 v216, v22, 5, v21
  v_bfe_u32 v23, v2, 2, 1
  v_lshl_add_u32 v216, v23, 4, v216
  s_sub_u32 s10, s4, 4
  s_mul_i32 s11, s10, 0x410
  v_add_u32 v216, s11, v216
  s_lshl_b32 s10, s10, 3
  v_mov_b32 v218, s10
  v_and_b32 v17, 7, v2
  v_lshl_add_u32 v17, v3, 3, v17
  v_lshlrev_b32 v17, 4, v17
  s_mov_b32 s20, s13
  v_and_b32 v225, 1, v3
  v_lshlrev_b32 v225, 3, v225
  v_bfe_u32 v18, v2, 2, 1
  v_lshl_add_u32 v225, v18, 2, v225
  v_lshrrev_b32 v18, 3, v2
  v_lshl_add_u32 v225, v18, 1, v225
  v_lshrrev_b32 v18, 1, v3
  v_add_u32 v225, v225, v18
  v_lshlrev_b32 v225, 2, v225
  v_and_b32 v231, 14, v2
  v_add_u32 v231, v231, v18
  v_lshlrev_b32 v231, 2, v231
  v_add_u32 v226, 0x2500, v225
  v_add_u32 v232, 0x2500, v231
  v_mov_b32 v228, 0xff61b1e6
  s_lshl_b32 s17, s3, 15
  s_add_u32 s17, s17, 0x200000
  s_cmp_lt_u32 s0, 28
  s_cselect_b32 s16, 40, 24
  s_sub_u32 s16, 0x80, s16
  s_mov_b32 s18, 0
  s_mov_b32 s19, 0
  s_sub_u32 s10, s4, 4
  s_lshl_b32 s29, s29, 2
  s_add_u32 s29, s29, s10
  s_lshl_b32 s26, s29, 6
  s_add_u32 s27, s26, 0x100
  s_lshl_b32 s10, s10, 6
  v_add_u32 v212, s10, v226
  v_mov_b32 v234, v212
  s_mov_b32 s1, 0
  s_mov_b32 s58, 0
  s_and_b32 s10, s3, 1
  s_lshl_b32 s10, s10, 8
  s_add_u32 s10, s10, s3
  s_cmp_lt_u32 s10, 56
  s_cselect_b32 s30, 40, 24
  s_mov_b32 s13, 0x186a00
L_qw_19:
  ds_read_b32 v16, v214 offset:4
  s_waitcnt lgkmcnt(0)
  v_readfirstlane_b32 s10, v16
  s_nop 0
  s_cmp_lg_u32 s10, 0
  s_nop 2
  s_cbranch_scc1 L_qok_20
  s_sleep 2
  s_sub_u32 s13, s13, 1
  s_cmp_lg_u32 s13, 0
  s_cbranch_scc1 L_qw_19
L_qok_20:
  v_xor_b32 v18, 64, v17
  ds_read_b128 v[36:39], v17 offset:8704
  ds_read_b128 v[40:43], v18 offset:8704
  s_waitcnt lgkmcnt(0)
  v_cndmask_b32 v52, 0, v36, s[92:93]
  v_cndmask_b32 v56, v36, 0, s[92:93]
  v_cndmask_b32 v53, 0, v37, s[92:93]
  v_cndmask_b32 v57, v37, 0, s[92:93]
  v_cndmask_b32 v54, 0, v38, s[92:93]
  v_cndmask_b32 v58, v38, 0, s[92:93]
  v_cndmask_b32 v55, 0, v39, s[92:93]
  v_cndmask_b32 v59, v39, 0, s[92:93]
  v_cndmask_b32 v60, 0, v40, s[92:93]
  v_cndmask_b32 v64, v40, 0, s[92:93]
  v_cndmask_b32 v61, 0, v41, s[92:93]
  v_cndmask_b32 v65, v41, 0, s[92:93]
  v_cndmask_b32 v62, 0, v42, s[92:93]
  v_cndmask_b32 v66, v42, 0, s[92:93]
  v_cndmask_b32 v63, 0, v43, s[92:93]
  v_cndmask_b32 v67, v43, 0, s[92:93]
  v_mov_b32 v235, 0x2494
  s_mov_b64 exec, 1
  ds_add_rtn_u32 v212, v235, v213
  s_mov_b64 exec, -1
L_half0:
  s_cmp_eq_u32 s18, 4
  s_cbranch_scc1 L_flush_21
  s_mov_b32 s56, s18
  s_mov_b32 s57, s26
  s_bitcmp1_b32 s1, 0
  s_cbranch_scc1 L_sp_23
L_sv_24:
  s_waitcnt lgkmcnt(0)
  v_readfirstlane_b32 s10, v212
  s_nop 0
  s_cmp_ge_u32 s10, s16
  s_nop 2
  s_cbranch_scc1 L_np_25
  s_mov_b64 exec, 1
  ds_add_rtn_u32 v212, v235, v213
  s_mov_b64 exec, -1
  s_lshl_b32 s26, s10, 6
  s_lshl_b32 s8, s7, 7
  s_add_u32 s8, s8, s10
  s_branch L_tile_26
L_np_25:
  s_mov_b32 s15, 1
  s_lshl_b32 s10, s1, 6
  s_atomic_add s15, s[80:81], s10 glc
  s_add_u32 s1, s1, 1
L_sp_23:
  s_waitcnt lgkmcnt(0)
  s_min_u32 s10, s15, 0x1000
  s_add_u32 s11, s30, 0x48
  s_cmp_ge_u32 s10, s11
  s_cbranch_scc1 L_ex_27
  s_mov_b32 s15, 1
  s_and_b32 s11, s1, 2
  s_lshl_b32 s11, s11, 6
  s_atomic_add s15, s[80:81], s11 glc
  s_sub_u32 s11, s10, s30
  s_mul_i32 s12, s11, 0xaab
  s_lshr_b32 s12, s12, 16
  s_mul_i32 s8, s12, 0x68
  s_add_u32 s8, s8, s11
  s_add_u32 s8, s8, 0xe8
  s_add_u32 s11, s11, 0x80
  s_cmp_lt_u32 s10, s30
  s_cselect_b32 s8, s11, s8
  s_lshl_b32 s26, s8, 6
  s_add_u32 s26, s26, s17
L_tile_26:
  s_mov_b32 s18, s1
  s_lshl_b32 s31, s8, 13
  s_and_b32 s11, s8, 3
  s_lshl_b32 s11, s11, 12
  s_sub_u32 s31, s31, s11
  s_branch L_sd_22
L_ex_27:
  s_cmp_eq_u32 s1, 3
  s_cbranch_scc1 L_en_28
  s_mov_b32 s1, 2
  v_add_u32 v235, 4, v235
  s_mov_b64 exec, 1
  ds_add_rtn_u32 v212, v235, v213
  s_mov_b64 exec, -1
  s_branch L_sv_24
L_en_28:
  s_mov_b32 s18, 4
  s_mov_b32 s31, 0x800000
L_sd_22:
  s_cmp_ge_u32 s56, 2
  s_cbranch_scc1 L_vpath_29
  s_cmp_ge_u32 s18, 2
  s_cbranch_scc1 L_kv_30
  s_waitcnt vmcnt(15)
  v_mfma_f32_16x16x32_bf16 v[68:71], v[84:87], v[52:55], 0
  buffer_load_dwordx4 v[84:87], v4, s[40:43], s31 offen nt
  s_waitcnt vmcnt(15)
  v_mfma_f32_16x16x32_bf16 v[68:71], v[88:91], v[56:59], v[68:71]
  buffer_load_dwordx4 v[88:91], v4, s[40:43], s31 offen offset:1024 nt
  s_waitcnt vmcnt(15)
  v_mfma_f32_16x16x32_bf16 v[72:75], v[92:95], v[60:63], 0
  buffer_load_dwordx4 v[92:95], v4, s[40:43], s31 offen offset:2048 nt
  s_waitcnt vmcnt(15)
  v_mfma_f32_16x16x32_bf16 v[72:75], v[96:99], v[64:67], v[72:75]
  buffer_load_dwordx4 v[96:99], v4, s[40:43], s31 offen offset:3072 nt
  s_waitcnt vmcnt(15)
  v_mfma_f32_16x16x32_bf16 v[76:79], v[100:103], v[52:55], 0
  buffer_load_dwordx4 v[100:103], v5, s[40:43], s31 offen nt
  s_waitcnt vmcnt(15)
  v_mfma_f32_16x16x32_bf16 v[76:79], v[104:107], v[56:59], v[76:79]
  buffer_load_dwordx4 v[104:107], v5, s[40:43], s31 offen offset:1024 nt
  s_waitcnt vmcnt(15)
  v_mfma_f32_16x16x32_bf16 v[80:83], v[108:111], v[60:63], 0
  buffer_load_dwordx4 v[108:111], v5, s[40:43], s31 offen offset:2048 nt
  s_waitcnt vmcnt(15)
  v_mfma_f32_16x16x32_bf16 v[80:83], v[112:115], v[64:67], v[80:83]
  buffer_load_dwordx4 v[112:115], v5, s[40:43], s31 offen offset:3072 nt
  s_nop 6
  s_branch L_kr_31
L_kv_30:
  s_waitcnt vmcnt(15)
  v_mfma_f32_16x16x32_bf16 v[68:71], v[84:87], v[52:55], 0
  buffer_load_dwordx4 v[84:87], v6, s[44:47], s31 offen nt
  s_waitcnt vmcnt(15)
  v_mfma_f32_16x16x32_bf16 v[68:71], v[88:91], v[56:59], v[68:71]
  buffer_load_dwordx4 v[88:91], v6, s[44:47], s31 offen offset:1024 nt
  s_waitcnt vmcnt(15)
  v_mfma_f32_16x16x32_bf16 v[72:75], v[92:95], v[60:63], 0
  buffer_load_dwordx4 v[92:95], v6, s[44:47], s31 offen offset:2048 nt
  s_waitcnt vmcnt(15)
  v_mfma_f32_16x16x32_bf16 v[72:75], v[96:99], v[64:67], v[72:75]
  buffer_load_dwordx4 v[96:99], v6, s[44:47], s31 offen offset:3072 nt
  s_waitcnt vmcnt(15)
  v_mfma_f32_16x16x32_bf16 v[76:79], v[100:103], v[52:55], 0
  buffer_load_dwordx4 v[100:103], v7, s[44:47], s31 offen nt
  s_waitcnt vmcnt(15)
  v_mfma_f32_16x16x32_bf16 v[76:79], v[104:107], v[56:59], v[76:79]
  buffer_load_dwordx4 v[104:107], v7, s[44:47], s31 offen offset:1024 nt
  s_waitcnt vmcnt(15)
  v_mfma_f32_16x16x32_bf16 v[80:83], v[108:111], v[60:63], 0
  buffer_load_dwordx4 v[108:111], v7, s[44:47], s31 offen offset:2048 nt
  s_waitcnt vmcnt(15)
  v_mfma_f32_16x16x32_bf16 v[80:83], v[112:115], v[64:67], v[80:83]
  buffer_load_dwordx4 v[112:115], v7, s[44:47], s31 offen offset:3072 nt
  s_nop 6
L_kr_31:
  v_mov_b32_dpp v32, v68 quad_perm:[0,0,0,0] row_mask:0xf bank_mask:0xf
  v_mov_b32_dpp v33, v72 quad_perm:[0,0,0,0] row_mask:0xf bank_mask:0xf
  v_mov_b32_dpp v34, v76 quad_perm:[0,0,0,0] row_mask:0xf bank_mask:0xf
  v_mov_b32_dpp v35, v80 quad_perm:[0,0,0,0] row_mask:0xf bank_mask:0xf
  v_add_f32_dpp v32, v69, v32 quad_perm:[1,1,1,1] row_mask:0xf bank_mask:0xf
  v_add_f32_dpp v33, v73, v33 quad_perm:[1,1,1,1] row_mask:0xf bank_mask:0xf
  v_add_f32_dpp v34, v77, v34 quad_perm:[1,1,1,1] row_mask:0xf bank_mask:0xf
  v_add_f32_dpp v35, v81, v35 quad_perm:[1,1,1,1] row_mask:0xf bank_mask:0xf
  v_add_f32_dpp v32, v70, v32 quad_perm:[2,2,2,2] row_mask:0xf bank_mask:0xf
  v_add_f32_dpp v33, v74, v33 quad_perm:[2,2,2,2] row_mask:0xf bank_mask:0xf
  v_add_f32_dpp v34, v78, v34 quad_perm:[2,2,2,2] row_mask:0xf bank_mask:0xf
  v_add_f32_dpp v35, v82, v35 quad_perm:[2,2,2,2] row_mask:0xf bank_mask:0xf
  v_add_f32_dpp v32, v71, v32 quad_perm:[3,3,3,3] row_mask:0xf bank_mask:0xf
  v_add_f32_dpp v33, v75, v33 quad_perm:[3,3,3,3] row_mask:0xf bank_mask:0xf
  v_add_f32_dpp v34, v79, v34 quad_perm:[3,3,3,3] row_mask:0xf bank_mask:0xf
  v_add_f32_dpp v35, v83, v35 quad_perm:[3,3,3,3] row_mask:0xf bank_mask:0xf
  v_cndmask_b32 v32, v33, v32, s[84:85]
  v_cndmask_b32 v34, v35, v34, s[84:85]
  s_nop 1
  v_permlane16_swap_b32 v32, v34
  s_nop 1
  v_add_f32_dpp v16, v34, v32 row_half_mirror row_mask:0xf bank_mask:0xf
  v_cvt_pk_bf16_f32 v16, v16, v16
  v_and_b32 v16, 0xffff0000, v16
  s_cmp_lg_u32 s56, 0
  s_nop 0
  s_cbranch_scc1 L_kp_32
  v_add_u32 v227, s57, v226
  ds_write_b32 v227, v16
  v_max_f32 v228, v228, v16
  s_nop 1
  s_branch L_half1
L_kp_32:
  buffer_store_dword v16, v225, s[76:79], s57 offen sc1
  s_branch L_half1
L_vpath_29:
  s_cmp_lg_u32 s58, 0
  s_cbranch_scc1 L_gm_33
  s_mov_b32 s58, 1
  v_max_f32_dpp v228, v228, v228 row_ror:4 row_mask:0xf bank_mask:0xf
  s_nop 1
  v_max_f32_dpp v228, v228, v228 row_ror:8 row_mask:0xf bank_mask:0xf
  s_nop 1
  v_max_f32_dpp v228, v228, v228 row_bcast:15 row_mask:0xa bank_mask:0xf
  s_nop 1
  v_max_f32_dpp v228, v228, v228 row_bcast:31 row_mask:0xc bank_mask:0xf
  s_nop 0
  v_readlane_b32 s38, v228, 63
  s_mov_b64 exec, 1
  ds_add_u32 v214, v213
  s_mov_b64 exec, -1
  s_nop 1
L_gm_33:
  s_cmp_eq_u32 s56, 3
  s_cbranch_scc1 L_vp_34
  v_add_u32 v227, s57, v232
  s_mov_b32 s13, 0x186a00
  s_nop 0
L_ls_36:
  ds_read_b32 v16, v227
  s_waitcnt lgkmcnt(0)
  v_cmp_eq_u32 vcc, -1, v16
  s_nop 0
  s_cmp_eq_u64 vcc, 0
  s_nop 2
  s_cbranch_scc1 L_sm_37
  s_sub_u32 s13, s13, 1
  s_cmp_lg_u32 s13, 0
  s_cbranch_scc1 L_ls_36
  s_branch L_sm_37
L_vp_34:
  s_waitcnt vmcnt(15)
  v_cmp_eq_u32 vcc, -1, v229
  s_nop 0
  s_cmp_eq_u64 vcc, 0
  s_nop 2
  s_cbranch_scc1 L_done_38
  s_mov_b32 s13, 0x30d40
L_spin_39:
  buffer_load_dword v229, v231, s[76:79], s57 offen sc1
  s_waitcnt vmcnt(0)
  v_cmp_eq_u32 vcc, -1, v229
  s_nop 0
  s_cmp_eq_u64 vcc, 0
  s_nop 2
  s_cbranch_scc1 L_done_38
  s_sleep 8
  s_sub_u32 s13, s13, 1
  s_cmp_lg_u32 s13, 0
  s_cbranch_scc1 L_spin_39
L_done_38:
  v_mov_b32 v16, v229
  s_nop 1
L_sm_37:
  v_max_f32 v17, s38, v16
  s_nop 1
  v_max_f32_dpp v17, v17, v17 quad_perm:[1,0,3,2] row_mask:0xf bank_mask:0xf
  s_nop 1
  v_max_f32_dpp v17, v17, v17 quad_perm:[2,3,0,1] row_mask:0xf bank_mask:0xf
  s_nop 1
  v_max_f32_dpp v17, v17, v17 row_half_mirror row_mask:0xf bank_mask:0xf
  s_nop 1
  v_max_f32_dpp v17, v17, v17 row_mirror row_mask:0xf bank_mask:0xf
  s_nop 1
  v_max_f32_dpp v17, v17, v17 row_bcast:15 row_mask:0xa bank_mask:0xf
  s_nop 1
  v_max_f32_dpp v17, v17, v17 row_bcast:31 row_mask:0xc bank_mask:0xf
  s_nop 0
  v_readlane_b32 s39, v17, 63
  v_mov_b32 v17, s38
  s_nop 0
  v_subrev_f32 v16, s39, v16
  v_subrev_f32 v17, s39, v17
  v_mul_f32 v16, s83, v16
  v_mul_f32 v17, s83, v17
  v_exp_f32 v16, v16
  v_exp_f32 v17, v17
  s_mov_b32 s38, s39
  v_fma_f32 v14, v14, v17, v16
  v_cvt_pk_bf16_f32 v233, v16, v16
  v_mul_f32 v24, v24, v17
  v_mul_f32 v25, v25, v17
  v_mul_f32 v26, v26, v17
  v_mul_f32 v27, v27, v17
  s_cmp_lg_u32 s18, 3
  s_nop 0
  s_cbranch_scc1 L_ns_40
  buffer_load_dword v229, v231, s[76:79], s26 offen sc1
L_ns_40:
  v_and_b32_dpp v36, v233, v8 row_newbcast:0 row_mask:0xf bank_mask:0xf
  v_and_b32_dpp v37, v233, v9 row_newbcast:0 row_mask:0xf bank_mask:0xf
  v_and_b32_dpp v38, v233, v10 row_newbcast:0 row_mask:0xf bank_mask:0xf
  v_and_b32_dpp v39, v233, v11 row_newbcast:0 row_mask:0xf bank_mask:0xf
  v_and_b32_dpp v40, v233, v8 row_newbcast:2 row_mask:0xf bank_mask:0xf
  v_and_b32_dpp v41, v233, v9 row_newbcast:2 row_mask:0xf bank_mask:0xf
  v_and_b32_dpp v42, v233, v10 row_newbcast:2 row_mask:0xf bank_mask:0xf
  v_and_b32_dpp v43, v233, v11 row_newbcast:2 row_mask:0xf bank_mask:0xf
  v_and_b32_dpp v44, v233, v8 row_newbcast:4 row_mask:0xf bank_mask:0xf
  v_and_b32_dpp v45, v233, v9 row_newbcast:4 row_mask:0xf bank_mask:0xf
  v_and_b32_dpp v46, v233, v10 row_newbcast:4 row_mask:0xf bank_mask:0xf
  v_and_b32_dpp v47, v233, v11 row_newbcast:4 row_mask:0xf bank_mask:0xf
  v_and_b32_dpp v48, v233, v8 row_newbcast:6 row_mask:0xf bank_mask:0xf
  v_and_b32_dpp v49, v233, v9 row_newbcast:6 row_mask:0xf bank_mask:0xf
  v_and_b32_dpp v50, v233, v10 row_newbcast:6 row_mask:0xf bank_mask:0xf
  v_and_b32_dpp v51, v233, v11 row_newbcast:6 row_mask:0xf bank_mask:0xf
  s_waitcnt vmcnt(15)
  v_mfma_f32_16x16x32_bf16 v[24:27], v[84:87], v[36:39], v[24:27]
  buffer_load_dwordx4 v[84:87], v6, s[44:47], s31 offen nt
  v_and_b32_dpp v36, v233, v8 row_newbcast:8 row_mask:0xf bank_mask:0xf
  v_and_b32_dpp v37, v233, v9 row_newbcast:8 row_mask:0xf bank_mask:0xf
  v_and_b32_dpp v38, v233, v10 row_newbcast:8 row_mask:0xf bank_mask:0xf
  v_and_b32_dpp v39, v233, v11 row_newbcast:8 row_mask:0xf bank_mask:0xf
  s_waitcnt vmcnt(15)
  v_mfma_f32_16x16x32_bf16 v[24:27], v[88:91], v[40:43], v[24:27]
  buffer_load_dwordx4 v[88:91], v6, s[44:47], s31 offen offset:1024 nt
  v_and_b32_dpp v40, v233, v8 row_newbcast:10 row_mask:0xf bank_mask:0xf
  v_and_b32_dpp v41, v233, v9 row_newbcast:10 row_mask:0xf bank_mask:0xf
  v_and_b32_dpp v42, v233, v10 row_newbcast:10 row_mask:0xf bank_mask:0xf
  v_and_b32_dpp v43, v233, v11 row_newbcast:10 row_mask:0xf bank_mask:0xf
  s_waitcnt vmcnt(15)
  v_mfma_f32_16x16x32_bf16 v[24:27], v[92:95], v[44:47], v[24:27]
  buffer_load_dwordx4 v[92:95], v6, s[44:47], s31 offen offset:2048 nt
  v_and_b32_dpp v44, v233, v8 row_newbcast:12 row_mask:0xf bank_mask:0xf
  v_and_b32_dpp v45, v233, v9 row_newbcast:12 row_mask:0xf bank_mask:0xf
  v_and_b32_dpp v46, v233, v10 row_newbcast:12 row_mask:0xf bank_mask:0xf
  v_and_b32_dpp v47, v233, v11 row_newbcast:12 row_mask:0xf bank_mask:0xf
  s_waitcnt vmcnt(15)
  v_mfma_f32_16x16x32_bf16 v[24:27], v[96:99], v[48:51], v[24:27]
  buffer_load_dwordx4 v[96:99], v6, s[44:47], s31 offen offset:3072 nt
  v_and_b32_dpp v48, v233, v8 row_newbcast:14 row_mask:0xf bank_mask:0xf
  v_and_b32_dpp v49, v233, v9 row_newbcast:14 row_mask:0xf bank_mask:0xf
  v_and_b32_dpp v50, v233, v10 row_newbcast:14 row_mask:0xf bank_mask:0xf
  v_and_b32_dpp v51, v233, v11 row_newbcast:14 row_mask:0xf bank_mask:0xf
  s_waitcnt vmcnt(15)
  v_mfma_f32_16x16x32_bf16 v[24:27], v[100:103], v[36:39], v[24:27]
  buffer_load_dwordx4 v[100:103], v7, s[44:47], s31 offen nt
  s_waitcnt vmcnt(15)
  v_mfma_f32_16x16x32_bf16 v[24:27], v[104:107], v[40:43], v[24:27]
  buffer_load_dwordx4 v[104:107], v7, s[44:47], s31 offen offset:1024 nt
  s_waitcnt vmcnt(15)
  v_mfma_f32_16x16x32_bf16 v[24:27], v[108:111], v[44:47], v[24:27]
  buffer_load_dwordx4 v[108:111], v7, s[44:47], s31 offen offset:2048 nt
  s_waitcnt vmcnt(15)
  v_mfma_f32_16x16x32_bf16 v[24:27], v[112:115], v[48:51], v[24:27]
  buffer_load_dwordx4 v[112:115], v7, s[44:47], s31 offen offset:3072 nt
  s_nop 6
L_half1:
  s_cmp_eq_u32 s19, 4
  s_cbranch_scc1 L_flush_21
  s_mov_b32 s56, s19
  s_mov_b32 s57, s27
  s_bitcmp1_b32 s1, 0
  s_cbranch_scc1 L_sp_42
L_sv_43:
  s_waitcnt lgkmcnt(0)
  v_readfirstlane_b32 s10, v212
  s_nop 0
  s_cmp_ge_u32 s10, s16
  s_nop 2
  s_cbranch_scc1 L_np_44
  s_mov_b64 exec, 1
  ds_add_rtn_u32 v212, v235, v213
  s_mov_b64 exec, -1
  s_lshl_b32 s27, s10, 6
  s_lshl_b32 s8, s7, 7
  s_add_u32 s8, s8, s10
  s_branch L_tile_45
L_np_44:
  s_mov_b32 s15, 1
  s_lshl_b32 s10, s1, 6
  s_atomic_add s15, s[80:81], s10 glc
  s_add_u32 s1, s1, 1
L_sp_42:
  s_waitcnt lgkmcnt(0)
  s_min_u32 s10, s15, 0x1000
  s_add_u32 s11, s30, 0x48
  s_cmp_ge_u32 s10, s11
  s_cbranch_scc1 L_ex_46
  s_mov_b32 s15, 1
  s_and_b32 s11, s1, 2
  s_lshl_b32 s11, s11, 6
  s_atomic_add s15, s[80:81], s11 glc
  s_sub_u32 s11, s10, s30
  s_mul_i32 s12, s11, 0xaab
  s_lshr_b32 s12, s12, 16
  s_mul_i32 s8, s12, 0x68
  s_add_u32 s8, s8, s11
  s_add_u32 s8, s8, 0xe8
  s_add_u32 s11, s11, 0x80
  s_cmp_lt_u32 s10, s30
  s_cselect_b32 s8, s11, s8
  s_lshl_b32 s27, s8, 6
  s_add_u32 s27, s27, s17
L_tile_45:
  s_mov_b32 s19, s1
  s_lshl_b32 s31, s8, 13
  s_and_b32 s11, s8, 3
  s_lshl_b32 s11, s11, 12
  s_sub_u32 s31, s31, s11
  s_branch L_sd_41
L_ex_46:
  s_cmp_eq_u32 s1, 3
  s_cbranch_scc1 L_en_47
  s_mov_b32 s1, 2
  v_add_u32 v235, 4, v235
  s_mov_b64 exec, 1
  ds_add_rtn_u32 v212, v235, v213
  s_mov_b64 exec, -1
  s_branch L_sv_43
L_en_47:
  s_mov_b32 s19, 4
  s_mov_b32 s31, 0x800000
L_sd_41:
  s_cmp_ge_u32 s56, 2
  s_cbranch_scc1 L_vpath_48
  s_cmp_ge_u32 s19, 2
  s_cbranch_scc1 L_kv_49
  s_waitcnt vmcnt(15)
  v_mfma_f32_16x16x32_bf16 v[68:71], v[116:119], v[52:55], 0
  buffer_load_dwordx4 v[116:119], v4, s[40:43], s31 offen nt
  s_waitcnt vmcnt(15)
  v_mfma_f32_16x16x32_bf16 v[68:71], v[120:123], v[56:59], v[68:71]
  buffer_load_dwordx4 v[120:123], v4, s[40:43], s31 offen offset:1024 nt
  s_waitcnt vmcnt(15)
  v_mfma_f32_16x16x32_bf16 v[72:75], v[124:127], v[60:63], 0
  buffer_load_dwordx4 v[124:127], v4, s[40:43], s31 offen offset:2048 nt
  s_waitcnt vmcnt(15)
  v_mfma_f32_16x16x32_bf16 v[72:75], v[128:131], v[64:67], v[72:75]
  buffer_load_dwordx4 v[128:131], v4, s[40:43], s31 offen offset:3072 nt
  s_waitcnt vmcnt(15)
  v_mfma_f32_16x16x32_bf16 v[76:79], v[132:135], v[52:55], 0
  buffer_load_dwordx4 v[132:135], v5, s[40:43], s31 offen nt
  s_waitcnt vmcnt(15)
  v_mfma_f32_16x16x32_bf16 v[76:79], v[136:139], v[56:59], v[76:79]
  buffer_load_dwordx4 v[136:139], v5, s[40:43], s31 offen offset:1024 nt
  s_waitcnt vmcnt(15)
  v_mfma_f32_16x16x32_bf16 v[80:83], v[140:143], v[60:63], 0
  buffer_load_dwordx4 v[140:143], v5, s[40:43], s31 offen offset:2048 nt
  s_waitcnt vmcnt(15)
  v_mfma_f32_16x16x32_bf16 v[80:83], v[144:147], v[64:67], v[80:83]
  buffer_load_dwordx4 v[144:147], v5, s[40:43], s31 offen offset:3072 nt
  s_nop 6
  s_branch L_kr_50
L_kv_49:
  s_waitcnt vmcnt(15)
  v_mfma_f32_16x16x32_bf16 v[68:71], v[116:119], v[52:55], 0
  buffer_load_dwordx4 v[116:119], v6, s[44:47], s31 offen nt
  s_waitcnt vmcnt(15)
  v_mfma_f32_16x16x32_bf16 v[68:71], v[120:123], v[56:59], v[68:71]
  buffer_load_dwordx4 v[120:123], v6, s[44:47], s31 offen offset:1024 nt
  s_waitcnt vmcnt(15)
  v_mfma_f32_16x16x32_bf16 v[72:75], v[124:127], v[60:63], 0
  buffer_load_dwordx4 v[124:127], v6, s[44:47], s31 offen offset:2048 nt
  s_waitcnt vmcnt(15)
  v_mfma_f32_16x16x32_bf16 v[72:75], v[128:131], v[64:67], v[72:75]
  buffer_load_dwordx4 v[128:131], v6, s[44:47], s31 offen offset:3072 nt
  s_waitcnt vmcnt(15)
  v_mfma_f32_16x16x32_bf16 v[76:79], v[132:135], v[52:55], 0
  buffer_load_dwordx4 v[132:135], v7, s[44:47], s31 offen nt
  s_waitcnt vmcnt(15)
  v_mfma_f32_16x16x32_bf16 v[76:79], v[136:139], v[56:59], v[76:79]
  buffer_load_dwordx4 v[136:139], v7, s[44:47], s31 offen offset:1024 nt
  s_waitcnt vmcnt(15)
  v_mfma_f32_16x16x32_bf16 v[80:83], v[140:143], v[60:63], 0
  buffer_load_dwordx4 v[140:143], v7, s[44:47], s31 offen offset:2048 nt
  s_waitcnt vmcnt(15)
  v_mfma_f32_16x16x32_bf16 v[80:83], v[144:147], v[64:67], v[80:83]
  buffer_load_dwordx4 v[144:147], v7, s[44:47], s31 offen offset:3072 nt
  s_nop 6
L_kr_50:
  v_mov_b32_dpp v32, v68 quad_perm:[0,0,0,0] row_mask:0xf bank_mask:0xf
  v_mov_b32_dpp v33, v72 quad_perm:[0,0,0,0] row_mask:0xf bank_mask:0xf
  v_mov_b32_dpp v34, v76 quad_perm:[0,0,0,0] row_mask:0xf bank_mask:0xf
  v_mov_b32_dpp v35, v80 quad_perm:[0,0,0,0] row_mask:0xf bank_mask:0xf
  v_add_f32_dpp v32, v69, v32 quad_perm:[1,1,1,1] row_mask:0xf bank_mask:0xf
  v_add_f32_dpp v33, v73, v33 quad_perm:[1,1,1,1] row_mask:0xf bank_mask:0xf
  v_add_f32_dpp v34, v77, v34 quad_perm:[1,1,1,1] row_mask:0xf bank_mask:0xf
  v_add_f32_dpp v35, v81, v35 quad_perm:[1,1,1,1] row_mask:0xf bank_mask:0xf
  v_add_f32_dpp v32, v70, v32 quad_perm:[2,2,2,2] row_mask:0xf bank_mask:0xf
  v_add_f32_dpp v33, v74, v33 quad_perm:[2,2,2,2] row_mask:0xf bank_mask:0xf
  v_add_f32_dpp v34, v78, v34 quad_perm:[2,2,2,2] row_mask:0xf bank_mask:0xf
  v_add_f32_dpp v35, v82, v35 quad_perm:[2,2,2,2] row_mask:0xf bank_mask:0xf
  v_add_f32_dpp v32, v71, v32 quad_perm:[3,3,3,3] row_mask:0xf bank_mask:0xf
  v_add_f32_dpp v33, v75, v33 quad_perm:[3,3,3,3] row_mask:0xf bank_mask:0xf
  v_add_f32_dpp v34, v79, v34 quad_perm:[3,3,3,3] row_mask:0xf bank_mask:0xf
  v_add_f32_dpp v35, v83, v35 quad_perm:[3,3,3,3] row_mask:0xf bank_mask:0xf
  v_cndmask_b32 v32, v33, v32, s[84:85]
  v_cndmask_b32 v34, v35, v34, s[84:85]
  s_nop 1
  v_permlane16_swap_b32 v32, v34
  s_nop 1
  v_add_f32_dpp v16, v34, v32 row_half_mirror row_mask:0xf bank_mask:0xf
  v_cvt_pk_bf16_f32 v16, v16, v16
  v_and_b32 v16, 0xffff0000, v16
  s_cmp_lg_u32 s56, 0
  s_nop 0
  s_cbranch_scc1 L_kp_51
  v_add_u32 v227, s57, v226
  ds_write_b32 v227, v16
  v_max_f32 v228, v228, v16
  s_cmp_lg_u32 s82, 0
  s_nop 0
  s_cbranch_scc1 L_nox_52
  s_mov_b32 s82, 1
  v_mfma_f32_16x16x32_bf16 v[68:71], v[148:151], v[52:55], 0
  v_mfma_f32_16x16x32_bf16 v[68:71], v[152:155], v[56:59], v[68:71]
  v_mfma_f32_16x16x32_bf16 v[72:75], v[156:159], v[60:63], 0
  v_mfma_f32_16x16x32_bf16 v[72:75], v[160:163], v[64:67], v[72:75]
  v_mfma_f32_16x16x32_bf16 v[76:79], v[164:167], v[52:55], 0
  v_mfma_f32_16x16x32_bf16 v[76:79], v[168:171], v[56:59], v[76:79]
  v_mfma_f32_16x16x32_bf16 v[80:83], v[172:175], v[60:63], 0
  v_mfma_f32_16x16x32_bf16 v[80:83], v[176:179], v[64:67], v[80:83]
  s_nop 1
  v_mov_b32_dpp v32, v68 quad_perm:[0,0,0,0] row_mask:0xf bank_mask:0xf
  s_nop 0
  v_mov_b32_dpp v33, v72 quad_perm:[0,0,0,0] row_mask:0xf bank_mask:0xf
  s_nop 0
  v_mov_b32_dpp v34, v76 quad_perm:[0,0,0,0] row_mask:0xf bank_mask:0xf
  s_nop 0
  v_mov_b32_dpp v35, v80 quad_perm:[0,0,0,0] row_mask:0xf bank_mask:0xf
  v_add_f32_dpp v32, v69, v32 quad_perm:[1,1,1,1] row_mask:0xf bank_mask:0xf
  v_add_f32_dpp v33, v73, v33 quad_perm:[1,1,1,1] row_mask:0xf bank_mask:0xf
  v_add_f32_dpp v34, v77, v34 quad_perm:[1,1,1,1] row_mask:0xf bank_mask:0xf
  v_add_f32_dpp v35, v81, v35 quad_perm:[1,1,1,1] row_mask:0xf bank_mask:0xf
  v_add_f32_dpp v32, v70, v32 quad_perm:[2,2,2,2] row_mask:0xf bank_mask:0xf
  v_add_f32_dpp v33, v74, v33 quad_perm:[2,2,2,2] row_mask:0xf bank_mask:0xf
  v_add_f32_dpp v34, v78, v34 quad_perm:[2,2,2,2] row_mask:0xf bank_mask:0xf
  v_add_f32_dpp v35, v82, v35 quad_perm:[2,2,2,2] row_mask:0xf bank_mask:0xf
  v_add_f32_dpp v32, v71, v32 quad_perm:[3,3,3,3] row_mask:0xf bank_mask:0xf
  v_add_f32_dpp v33, v75, v33 quad_perm:[3,3,3,3] row_mask:0xf bank_mask:0xf
  v_add_f32_dpp v34, v79, v34 quad_perm:[3,3,3,3] row_mask:0xf bank_mask:0xf
  v_add_f32_dpp v35, v83, v35 quad_perm:[3,3,3,3] row_mask:0xf bank_mask:0xf
  v_cndmask_b32 v32, v33, v32, s[84:85]
  v_cndmask_b32 v34, v35, v34, s[84:85]
  s_nop 1
  v_permlane16_swap_b32 v32, v34
  s_nop 1
  v_add_f32_dpp v16, v34, v32 row_half_mirror row_mask:0xf bank_mask:0xf
  v_cvt_pk_bf16_f32 v16, v16, v16
  v_and_b32 v16, 0xffff0000, v16
  ds_write_b32 v234, v16
  v_max_f32 v228, v228, v16
  v_mfma_f32_16x16x32_bf16 v[68:71], v[180:183], v[52:55], 0
  v_mfma_f32_16x16x32_bf16 v[68:71], v[184:187], v[56:59], v[68:71]
  v_mfma_f32_16x16x32_bf16 v[72:75], v[188:191], v[60:63], 0
  v_mfma_f32_16x16x32_bf16 v[72:75], v[192:195], v[64:67], v[72:75]
  v_mfma_f32_16x16x32_bf16 v[76:79], v[196:199], v[52:55], 0
  v_mfma_f32_16x16x32_bf16 v[76:79], v[200:203], v[56:59], v[76:79]
  v_mfma_f32_16x16x32_bf16 v[80:83], v[204:207], v[60:63], 0
  v_mfma_f32_16x16x32_bf16 v[80:83], v[208:211], v[64:67], v[80:83]
  s_nop 1
  v_mov_b32_dpp v32, v68 quad_perm:[0,0,0,0] row_mask:0xf bank_mask:0xf
  s_nop 0
  v_mov_b32_dpp v33, v72 quad_perm:[0,0,0,0] row_mask:0xf bank_mask:0xf
  s_nop 0
  v_mov_b32_dpp v34, v76 quad_perm:[0,0,0,0] row_mask:0xf bank_mask:0xf
  s_nop 0
  v_mov_b32_dpp v35, v80 quad_perm:[0,0,0,0] row_mask:0xf bank_mask:0xf
  v_add_f32_dpp v32, v69, v32 quad_perm:[1,1,1,1] row_mask:0xf bank_mask:0xf
  v_add_f32_dpp v33, v73, v33 quad_perm:[1,1,1,1] row_mask:0xf bank_mask:0xf
  v_add_f32_dpp v34, v77, v34 quad_perm:[1,1,1,1] row_mask:0xf bank_mask:0xf
  v_add_f32_dpp v35, v81, v35 quad_perm:[1,1,1,1] row_mask:0xf bank_mask:0xf
  v_add_f32_dpp v32, v70, v32 quad_perm:[2,2,2,2] row_mask:0xf bank_mask:0xf
  v_add_f32_dpp v33, v74, v33 quad_perm:[2,2,2,2] row_mask:0xf bank_mask:0xf
  v_add_f32_dpp v34, v78, v34 quad_perm:[2,2,2,2] row_mask:0xf bank_mask:0xf
  v_add_f32_dpp v35, v82, v35 quad_perm:[2,2,2,2] row_mask:0xf bank_mask:0xf
  v_add_f32_dpp v32, v71, v32 quad_perm:[3,3,3,3] row_mask:0xf bank_mask:0xf
  v_add_f32_dpp v33, v75, v33 quad_perm:[3,3,3,3] row_mask:0xf bank_mask:0xf
  v_add_f32_dpp v34, v79, v34 quad_perm:[3,3,3,3] row_mask:0xf bank_mask:0xf
  v_add_f32_dpp v35, v83, v35 quad_perm:[3,3,3,3] row_mask:0xf bank_mask:0xf
  v_cndmask_b32 v32, v33, v32, s[84:85]
  v_cndmask_b32 v34, v35, v34, s[84:85]
  s_nop 1
  v_permlane16_swap_b32 v32, v34
  s_nop 1
  v_add_f32_dpp v16, v34, v32 row_half_mirror row_mask:0xf bank_mask:0xf
  v_cvt_pk_bf16_f32 v16, v16, v16
  v_and_b32 v16, 0xffff0000, v16
  ds_write_b32 v234, v16 offset:256
  v_max_f32 v228, v228, v16
  s_cmp_lt_u32 s0, 28
  s_nop 0
  s_cbranch_scc1 L_nox_52
  s_sub_u32 s12, s4, 4
  s_lshl_b32 s12, s12, 14
  s_add_u32 s12, s12, 0x8800
  v_add_u32 v18, s12, v15
  ds_read_b128 v[148:151], v18
  ds_read_b128 v[152:155], v18 offset:1024
  ds_read_b128 v[156:159], v18 offset:2048
  ds_read_b128 v[160:163], v18 offset:3072
  ds_read_b128 v[164:167], v18 offset:4096
  ds_read_b128 v[168:171], v18 offset:5120
  ds_read_b128 v[172:175], v18 offset:6144
  ds_read_b128 v[176:179], v18 offset:7168
  ds_read_b128 v[180:183], v18 offset:8192
  ds_read_b128 v[184:187], v18 offset:9216
  ds_read_b128 v[188:191], v18 offset:10240
  ds_read_b128 v[192:195], v18 offset:11264
  ds_read_b128 v[196:199], v18 offset:12288
  ds_read_b128 v[200:203], v18 offset:13312
  ds_read_b128 v[204:207], v18 offset:14336
  ds_read_b128 v[208:211], v18 offset:15360
  s_waitcnt lgkmcnt(0)
  v_mfma_f32_16x16x32_bf16 v[68:71], v[148:151], v[52:55], 0
  v_mfma_f32_16x16x32_bf16 v[68:71], v[152:155], v[56:59], v[68:71]
  v_mfma_f32_16x16x32_bf16 v[72:75], v[156:159], v[60:63], 0
  v_mfma_f32_16x16x32_bf16 v[72:75], v[160:163], v[64:67], v[72:75]
  v_mfma_f32_16x16x32_bf16 v[76:79], v[164:167], v[52:55], 0
  v_mfma_f32_16x16x32_bf16 v[76:79], v[168:171], v[56:59], v[76:79]
  v_mfma_f32_16x16x32_bf16 v[80:83], v[172:175], v[60:63], 0
  v_mfma_f32_16x16x32_bf16 v[80:83], v[176:179], v[64:67], v[80:83]
  s_nop 1
  v_mov_b32_dpp v32, v68 quad_perm:[0,0,0,0] row_mask:0xf bank_mask:0xf
  s_nop 0
  v_mov_b32_dpp v33, v72 quad_perm:[0,0,0,0] row_mask:0xf bank_mask:0xf
  s_nop 0
  v_mov_b32_dpp v34, v76 quad_perm:[0,0,0,0] row_mask:0xf bank_mask:0xf
  s_nop 0
  v_mov_b32_dpp v35, v80 quad_perm:[0,0,0,0] row_mask:0xf bank_mask:0xf
  v_add_f32_dpp v32, v69, v32 quad_perm:[1,1,1,1] row_mask:0xf bank_mask:0xf
  v_add_f32_dpp v33, v73, v33 quad_perm:[1,1,1,1] row_mask:0xf bank_mask:0xf
  v_add_f32_dpp v34, v77, v34 quad_perm:[1,1,1,1] row_mask:0xf bank_mask:0xf
  v_add_f32_dpp v35, v81, v35 quad_perm:[1,1,1,1] row_mask:0xf bank_mask:0xf
  v_add_f32_dpp v32, v70, v32 quad_perm:[2,2,2,2] row_mask:0xf bank_mask:0xf
  v_add_f32_dpp v33, v74, v33 quad_perm:[2,2,2,2] row_mask:0xf bank_mask:0xf
  v_add_f32_dpp v34, v78, v34 quad_perm:[2,2,2,2] row_mask:0xf bank_mask:0xf
  v_add_f32_dpp v35, v82, v35 quad_perm:[2,2,2,2] row_mask:0xf bank_mask:0xf
  v_add_f32_dpp v32, v71, v32 quad_perm:[3,3,3,3] row_mask:0xf bank_mask:0xf
  v_add_f32_dpp v33, v75, v33 quad_perm:[3,3,3,3] row_mask:0xf bank_mask:0xf
  v_add_f32_dpp v34, v79, v34 quad_perm:[3,3,3,3] row_mask:0xf bank_mask:0xf
  v_add_f32_dpp v35, v83, v35 quad_perm:[3,3,3,3] row_mask:0xf bank_mask:0xf
  v_cndmask_b32 v32, v33, v32, s[84:85]
  v_cndmask_b32 v34, v35, v34, s[84:85]
  s_nop 1
  v_permlane16_swap_b32 v32, v34
  s_nop 1
  v_add_f32_dpp v16, v34, v32 row_half_mirror row_mask:0xf bank_mask:0xf
  v_cvt_pk_bf16_f32 v16, v16, v16
  v_and_b32 v16, 0xffff0000, v16
  ds_write_b32 v234, v16 offset:512
  v_max_f32 v228, v228, v16
  v_mfma_f32_16x16x32_bf16 v[68:71], v[180:183], v[52:55], 0
  v_mfma_f32_16x16x32_bf16 v[68:71], v[184:187], v[56:59], v[68:71]
  v_mfma_f32_16x16x32_bf16 v[72:75], v[188:191], v[60:63], 0
  v_mfma_f32_16x16x32_bf16 v[72:75], v[192:195], v[64:67], v[72:75]
  v_mfma_f32_16x16x32_bf16 v[76:79], v[196:199], v[52:55], 0
  v_mfma_f32_16x16x32_bf16 v[76:79], v[200:203], v[56:59], v[76:79]
  v_mfma_f32_16x16x32_bf16 v[80:83], v[204:207], v[60:63], 0
  v_mfma_f32_16x16x32_bf16 v[80:83], v[208:211], v[64:67], v[80:83]
  s_nop 1
  v_mov_b32_dpp v32, v68 quad_perm:[0,0,0,0] row_mask:0xf bank_mask:0xf
  s_nop 0
  v_mov_b32_dpp v33, v72 quad_perm:[0,0,0,0] row_mask:0xf bank_mask:0xf
  s_nop 0
  v_mov_b32_dpp v34, v76 quad_perm:[0,0,0,0] row_mask:0xf bank_mask:0xf
  s_nop 0
  v_mov_b32_dpp v35, v80 quad_perm:[0,0,0,0] row_mask:0xf bank_mask:0xf
  v_add_f32_dpp v32, v69, v32 quad_perm:[1,1,1,1] row_mask:0xf bank_mask:0xf
  v_add_f32_dpp v33, v73, v33 quad_perm:[1,1,1,1] row_mask:0xf bank_mask:0xf
  v_add_f32_dpp v34, v77, v34 quad_perm:[1,1,1,1] row_mask:0xf bank_mask:0xf
  v_add_f32_dpp v35, v81, v35 quad_perm:[1,1,1,1] row_mask:0xf bank_mask:0xf
  v_add_f32_dpp v32, v70, v32 quad_perm:[2,2,2,2] row_mask:0xf bank_mask:0xf
  v_add_f32_dpp v33, v74, v33 quad_perm:[2,2,2,2] row_mask:0xf bank_mask:0xf
  v_add_f32_dpp v34, v78, v34 quad_perm:[2,2,2,2] row_mask:0xf bank_mask:0xf
  v_add_f32_dpp v35, v82, v35 quad_perm:[2,2,2,2] row_mask:0xf bank_mask:0xf
  v_add_f32_dpp v32, v71, v32 quad_perm:[3,3,3,3] row_mask:0xf bank_mask:0xf
  v_add_f32_dpp v33, v75, v33 quad_perm:[3,3,3,3] row_mask:0xf bank_mask:0xf
  v_add_f32_dpp v34, v79, v34 quad_perm:[3,3,3,3] row_mask:0xf bank_mask:0xf
  v_add_f32_dpp v35, v83, v35 quad_perm:[3,3,3,3] row_mask:0xf bank_mask:0xf
  v_cndmask_b32 v32, v33, v32, s[84:85]
  v_cndmask_b32 v34, v35, v34, s[84:85]
  s_nop 1
  v_permlane16_swap_b32 v32, v34
  s_nop 1
  v_add_f32_dpp v16, v34, v32 row_half_mirror row_mask:0xf bank_mask:0xf
  v_cvt_pk_bf16_f32 v16, v16, v16
  v_and_b32 v16, 0xffff0000, v16
  ds_write_b32 v234, v16 offset:768
  v_max_f32 v228, v228, v16
  s_nop 1
L_nox_52:
  s_branch L_half0
L_kp_51:
  buffer_store_dword v16, v225, s[76:79], s57 offen sc1
  s_branch L_half0
L_vpath_48:
  s_cmp_lg_u32 s58, 0
  s_cbranch_scc1 L_gm_53
  s_mov_b32 s58, 1
  v_max_f32_dpp v228, v228, v228 row_ror:4 row_mask:0xf bank_mask:0xf
  s_nop 1
  v_max_f32_dpp v228, v228, v228 row_ror:8 row_mask:0xf bank_mask:0xf
  s_nop 1
  v_max_f32_dpp v228, v228, v228 row_bcast:15 row_mask:0xa bank_mask:0xf
  s_nop 1
  v_max_f32_dpp v228, v228, v228 row_bcast:31 row_mask:0xc bank_mask:0xf
  s_nop 0
  v_readlane_b32 s38, v228, 63
  s_mov_b64 exec, 1
  ds_add_u32 v214, v213
  s_mov_b64 exec, -1
  s_nop 1
L_gm_53:
  s_cmp_eq_u32 s56, 3
  s_cbranch_scc1 L_vp_54
  v_add_u32 v227, s57, v232
  s_mov_b32 s13, 0x186a00
  s_nop 0
L_ls_56:
  ds_read_b32 v16, v227
  s_waitcnt lgkmcnt(0)
  v_cmp_eq_u32 vcc, -1, v16
  s_nop 0
  s_cmp_eq_u64 vcc, 0
  s_nop 2
  s_cbranch_scc1 L_sm_57
  s_sub_u32 s13, s13, 1
  s_cmp_lg_u32 s13, 0
  s_cbranch_scc1 L_ls_56
  s_branch L_sm_57
L_vp_54:
  s_waitcnt vmcnt(15)
  v_cmp_eq_u32 vcc, -1, v230
  s_nop 0
  s_cmp_eq_u64 vcc, 0
  s_nop 2
  s_cbranch_scc1 L_done_58
  s_mov_b32 s13, 0x30d40
L_spin_59:
  buffer_load_dword v230, v231, s[76:79], s57 offen sc1
  s_waitcnt vmcnt(0)
  v_cmp_eq_u32 vcc, -1, v230
  s_nop 0
  s_cmp_eq_u64 vcc, 0
  s_nop 2
  s_cbranch_scc1 L_done_58
  s_sleep 8
  s_sub_u32 s13, s13, 1
  s_cmp_lg_u32 s13, 0
  s_cbranch_scc1 L_spin_59
L_done_58:
  v_mov_b32 v16, v230
  s_nop 1
L_sm_57:
  v_max_f32 v17, s38, v16
  s_nop 1
  v_max_f32_dpp v17, v17, v17 quad_perm:[1,0,3,2] row_mask:0xf bank_mask:0xf
  s_nop 1
  v_max_f32_dpp v17, v17, v17 quad_perm:[2,3,0,1] row_mask:0xf bank_mask:0xf
  s_nop 1
  v_max_f32_dpp v17, v17, v17 row_half_mirror row_mask:0xf bank_mask:0xf
  s_nop 1
  v_max_f32_dpp v17, v17, v17 row_mirror row_mask:0xf bank_mask:0xf
  s_nop 1
  v_max_f32_dpp v17, v17, v17 row_bcast:15 row_mask:0xa bank_mask:0xf
  s_nop 1
  v_max_f32_dpp v17, v17, v17 row_bcast:31 row_mask:0xc bank_mask:0xf
  s_nop 0
  v_readlane_b32 s39, v17, 63
  v_mov_b32 v17, s38
  s_nop 0
  v_subrev_f32 v16, s39, v16
  v_subrev_f32 v17, s39, v17
  v_mul_f32 v16, s83, v16
  v_mul_f32 v17, s83, v17
  v_exp_f32 v16, v16
  v_exp_f32 v17, v17
  s_mov_b32 s38, s39
  v_fma_f32 v14, v14, v17, v16
  v_cvt_pk_bf16_f32 v233, v16, v16
  v_mul_f32 v24, v24, v17
  v_mul_f32 v25, v25, v17
  v_mul_f32 v26, v26, v17
  v_mul_f32 v27, v27, v17
  s_cmp_lg_u32 s19, 3
  s_nop 0
  s_cbranch_scc1 L_ns_60
  buffer_load_dword v230, v231, s[76:79], s27 offen sc1
L_ns_60:
  v_and_b32_dpp v36, v233, v8 row_newbcast:0 row_mask:0xf bank_mask:0xf
  v_and_b32_dpp v37, v233, v9 row_newbcast:0 row_mask:0xf bank_mask:0xf
  v_and_b32_dpp v38, v233, v10 row_newbcast:0 row_mask:0xf bank_mask:0xf
  v_and_b32_dpp v39, v233, v11 row_newbcast:0 row_mask:0xf bank_mask:0xf
  v_and_b32_dpp v40, v233, v8 row_newbcast:2 row_mask:0xf bank_mask:0xf
  v_and_b32_dpp v41, v233, v9 row_newbcast:2 row_mask:0xf bank_mask:0xf
  v_and_b32_dpp v42, v233, v10 row_newbcast:2 row_mask:0xf bank_mask:0xf
  v_and_b32_dpp v43, v233, v11 row_newbcast:2 row_mask:0xf bank_mask:0xf
  v_and_b32_dpp v44, v233, v8 row_newbcast:4 row_mask:0xf bank_mask:0xf
  v_and_b32_dpp v45, v233, v9 row_newbcast:4 row_mask:0xf bank_mask:0xf
  v_and_b32_dpp v46, v233, v10 row_newbcast:4 row_mask:0xf bank_mask:0xf
  v_and_b32_dpp v47, v233, v11 row_newbcast:4 row_mask:0xf bank_mask:0xf
  v_and_b32_dpp v48, v233, v8 row_newbcast:6 row_mask:0xf bank_mask:0xf
  v_and_b32_dpp v49, v233, v9 row_newbcast:6 row_mask:0xf bank_mask:0xf
  v_and_b32_dpp v50, v233, v10 row_newbcast:6 row_mask:0xf bank_mask:0xf
  v_and_b32_dpp v51, v233, v11 row_newbcast:6 row_mask:0xf bank_mask:0xf
  s_waitcnt vmcnt(15)
  v_mfma_f32_16x16x32_bf16 v[24:27], v[116:119], v[36:39], v[24:27]
  buffer_load_dwordx4 v[116:119], v6, s[44:47], s31 offen nt
  v_and_b32_dpp v36, v233, v8 row_newbcast:8 row_mask:0xf bank_mask:0xf
  v_and_b32_dpp v37, v233, v9 row_newbcast:8 row_mask:0xf bank_mask:0xf
  v_and_b32_dpp v38, v233, v10 row_newbcast:8 row_mask:0xf bank_mask:0xf
  v_and_b32_dpp v39, v233, v11 row_newbcast:8 row_mask:0xf bank_mask:0xf
  s_waitcnt vmcnt(15)
  v_mfma_f32_16x16x32_bf16 v[24:27], v[120:123], v[40:43], v[24:27]
  buffer_load_dwordx4 v[120:123], v6, s[44:47], s31 offen offset:1024 nt
  v_and_b32_dpp v40, v233, v8 row_newbcast:10 row_mask:0xf bank_mask:0xf
  v_and_b32_dpp v41, v233, v9 row_newbcast:10 row_mask:0xf bank_mask:0xf
  v_and_b32_dpp v42, v233, v10 row_newbcast:10 row_mask:0xf bank_mask:0xf
  v_and_b32_dpp v43, v233, v11 row_newbcast:10 row_mask:0xf bank_mask:0xf
  s_waitcnt vmcnt(15)
  v_mfma_f32_16x16x32_bf16 v[24:27], v[124:127], v[44:47], v[24:27]
  buffer_load_dwordx4 v[124:127], v6, s[44:47], s31 offen offset:2048 nt
  v_and_b32_dpp v44, v233, v8 row_newbcast:12 row_mask:0xf bank_mask:0xf
  v_and_b32_dpp v45, v233, v9 row_newbcast:12 row_mask:0xf bank_mask:0xf
  v_and_b32_dpp v46, v233, v10 row_newbcast:12 row_mask:0xf bank_mask:0xf
  v_and_b32_dpp v47, v233, v11 row_newbcast:12 row_mask:0xf bank_mask:0xf
  s_waitcnt vmcnt(15)
  v_mfma_f32_16x16x32_bf16 v[24:27], v[128:131], v[48:51], v[24:27]
  buffer_load_dwordx4 v[128:131], v6, s[44:47], s31 offen offset:3072 nt
  v_and_b32_dpp v48, v233, v8 row_newbcast:14 row_mask:0xf bank_mask:0xf
  v_and_b32_dpp v49, v233, v9 row_newbcast:14 row_mask:0xf bank_mask:0xf
  v_and_b32_dpp v50, v233, v10 row_newbcast:14 row_mask:0xf bank_mask:0xf
  v_and_b32_dpp v51, v233, v11 row_newbcast:14 row_mask:0xf bank_mask:0xf
  s_waitcnt vmcnt(15)
  v_mfma_f32_16x16x32_bf16 v[24:27], v[132:135], v[36:39], v[24:27]
  buffer_load_dwordx4 v[132:135], v7, s[44:47], s31 offen nt
  s_waitcnt vmcnt(15)
  v_mfma_f32_16x16x32_bf16 v[24:27], v[136:139], v[40:43], v[24:27]
  buffer_load_dwordx4 v[136:139], v7, s[44:47], s31 offen offset:1024 nt
  s_waitcnt vmcnt(15)
  v_mfma_f32_16x16x32_bf16 v[24:27], v[140:143], v[44:47], v[24:27]
  buffer_load_dwordx4 v[140:143], v7, s[44:47], s31 offen offset:2048 nt
  s_waitcnt vmcnt(15)
  v_mfma_f32_16x16x32_bf16 v[24:27], v[144:147], v[48:51], v[24:27]
  buffer_load_dwordx4 v[144:147], v7, s[44:47], s31 offen offset:3072 nt
  s_nop 6
  s_branch L_half0
L_flush_21:
  ds_write_b128 v216, v[24:27] offset:26112
  v_add_f32_dpp v14, v14, v14 quad_perm:[1,0,3,2] row_mask:0xf bank_mask:0xf
  s_nop 1
  v_add_f32_dpp v14, v14, v14 quad_perm:[2,3,0,1] row_mask:0xf bank_mask:0xf
  s_nop 1
  v_add_f32_dpp v14, v14, v14 row_half_mirror row_mask:0xf bank_mask:0xf
  s_nop 1
  v_add_f32_dpp v14, v14, v14 row_mirror row_mask:0xf bank_mask:0xf
  s_nop 1
  v_add_f32_dpp v14, v14, v14 row_bcast:15 row_mask:0xa bank_mask:0xf
  s_nop 1
  v_add_f32_dpp v14, v14, v14 row_bcast:31 row_mask:0xc bank_mask:0xf
  s_nop 0
  v_readlane_b32 s39, v14, 63
  v_mov_b32 v18, s38
  s_nop 0
  v_mov_b32 v19, s39
  v_mul_f32 v19, 0x3e800000, v19
  ds_write_b64 v218, v[18:19] offset:9216
  s_waitcnt lgkmcnt(0)
  s_barrier
  s_waitcnt vmcnt(0)
  s_setprio 0
L_b4:
  s_lshl_b32 s10, s4, 10
  v_add_u32 v20, s10, v15
  s_lshl_b32 s9, s3, 2
  s_add_u32 s9, s9, s7
  s_lshl_b32 s9, s9, 6
  s_lshl_b32 s8, s4, 18
  s_add_u32 s9, s9, s8
  s_add_u32 s9, s9, 0x100000
  s_waitcnt lgkmcnt(0)
  s_barrier
  s_cmp_ge_u32 s4, 2
  s_cbranch_scc1 L_nc_61
  ds_read_b128 v[116:119], v20 offset:17920
  ds_read_b128 v[120:123], v20 offset:19968
  ds_read_b128 v[124:127], v20 offset:22016
  ds_read_b128 v[128:131], v20 offset:24064
  s_cmp_lg_u32 s4, 1
  s_cbranch_scc1 L_y6_62
  s_mov_b32 exec_lo, 0
  s_mov_b32 exec_hi, 0xffff
  ds_read_b128 v[132:135], v20 offset:18176
  ds_read_b128 v[136:139], v20 offset:20224
  ds_read_b128 v[140:143], v20 offset:22272
  ds_read_b128 v[144:147], v20 offset:24320
  s_waitcnt lgkmcnt(0)
  v_add_f32 v116, v116, v132
  v_add_f32 v117, v117, v133
  v_add_f32 v118, v118, v134
  v_add_f32 v119, v119, v135
  v_add_f32 v120, v120, v136
  v_add_f32 v121, v121, v137
  v_add_f32 v122, v122, v138
  v_add_f32 v123, v123, v139
  v_add_f32 v124, v124, v140
  v_add_f32 v125, v125, v141
  v_add_f32 v126, v126, v142
  v_add_f32 v127, v127, v143
  v_add_f32 v128, v128, v144
  v_add_f32 v129, v129, v145
  v_add_f32 v130, v130, v146
  v_add_f32 v131, v131, v147
  s_mov_b32 exec_lo, -1
  s_nop 0
L_y6_62:
  s_waitcnt lgkmcnt(0)
  v_add_f32 v116, v116, v120
  v_add_f32 v124, v124, v128
  v_add_f32 v117, v117, v121
  v_add_f32 v125, v125, v129
  v_add_f32 v118, v118, v122
  v_add_f32 v126, v126, v130
  v_add_f32 v119, v119, v123
  v_add_f32 v127, v127, v131
  v_add_f32 v116, v116, v124
  v_add_f32 v117, v117, v125
  v_add_f32 v118, v118, v126
  v_add_f32 v119, v119, v127
  v_min_u32 v116, -2, v116
  v_min_u32 v117, -2, v117
  v_min_u32 v118, -2, v118
  v_min_u32 v119, -2, v119
  buffer_store_dwordx4 v[116:119], v220, s[76:79], s9 offen sc1
  s_mov_b64 exec, -1
  s_nop 0
L_nc_61:
  s_cmp_ge_u32 s0, 28
  s_cbranch_scc1 L_endp
  v_bfe_u32 v20, v1, 2, 2
  v_lshl_add_u32 v20, v3, 3, v20
  v_and_b32 v21, 3, v1
  v_lshlrev_b32 v21, 3, v21
  v_mul_u32_u24 v22, 0x380, v20
  v_add_u32 v22, v22, v21
  s_min_u32 s10, s4, 6
  s_lshl_b32 s10, s10, 7
  s_add_u32 s10, s10, 0x16800
  v_add_u32 v22, s10, v22
  ds_read_b64_tr_b16 v[84:85], v22
  ds_read_b64_tr_b16 v[86:87], v22 offset:3584
  ds_read_b64_tr_b16 v[88:89], v22 offset:28672
  ds_read_b64_tr_b16 v[90:91], v22 offset:32256
  ds_read_b64_tr_b16 v[92:93], v22 offset:32
  ds_read_b64_tr_b16 v[94:95], v22 offset:3616
  ds_read_b64_tr_b16 v[96:97], v22 offset:28704
  ds_read_b64_tr_b16 v[98:99], v22 offset:32288
  ds_read_b64_tr_b16 v[100:101], v22 offset:64
  ds_read_b64_tr_b16 v[102:103], v22 offset:3648
  ds_read_b64_tr_b16 v[104:105], v22 offset:28736
  ds_read_b64_tr_b16 v[106:107], v22 offset:32320
  ds_read_b64_tr_b16 v[108:109], v22 offset:96
  ds_read_b64_tr_b16 v[110:111], v22 offset:3680
  ds_read_b64_tr_b16 v[112:113], v22 offset:28768
  ds_read_b64_tr_b16 v[114:115], v22 offset:32352
  s_cmp_ge_u32 s4, 4
  s_cbranch_scc1 L_ln_63
  v_lshlrev_b32 v22, 7, v20
  v_add_u32 v22, v22, v21
  s_lshl_b32 s10, s4, 5
  s_add_u32 s10, s10, 0x8800
  v_add_u32 v22, s10, v22
  ds_read_b64_tr_b16 v[172:173], v22
  ds_read_b64_tr_b16 v[174:175], v22 offset:512
  ds_read_b64_tr_b16 v[176:177], v22 offset:4096
  ds_read_b64_tr_b16 v[178:179], v22 offset:4608
  ds_read_b64_tr_b16 v[180:181], v22 offset:8192
  ds_read_b64_tr_b16 v[182:183], v22 offset:8704
  ds_read_b64_tr_b16 v[184:185], v22 offset:12288
  ds_read_b64_tr_b16 v[186:187], v22 offset:12800
  s_waitcnt lgkmcnt(4)
  ds_read_b64_tr_b16 v[188:189], v22 offset:16384
  ds_read_b64_tr_b16 v[190:191], v22 offset:16896
  ds_read_b64_tr_b16 v[192:193], v22 offset:20480
  ds_read_b64_tr_b16 v[194:195], v22 offset:20992
  ds_read_b64_tr_b16 v[196:197], v22 offset:24576
  ds_read_b64_tr_b16 v[198:199], v22 offset:25088
  ds_read_b64_tr_b16 v[200:201], v22 offset:28672
  ds_read_b64_tr_b16 v[202:203], v22 offset:29184
  s_waitcnt lgkmcnt(4)
  ds_read_b64_tr_b16 v[204:205], v22 offset:32768
  ds_read_b64_tr_b16 v[206:207], v22 offset:33280
  ds_read_b64_tr_b16 v[208:209], v22 offset:36864
  ds_read_b64_tr_b16 v[210:211], v22 offset:37376
  ds_read_b64_tr_b16 v[212:213], v22 offset:40960
  ds_read_b64_tr_b16 v[214:215], v22 offset:41472
  ds_read_b64_tr_b16 v[216:217], v22 offset:45056
  ds_read_b64_tr_b16 v[218:219], v22 offset:45568
  s_waitcnt lgkmcnt(4)
  ds_read_b64_tr_b16 v[220:221], v22 offset:49152
  ds_read_b64_tr_b16 v[222:223], v22 offset:49664
  ds_read_b64_tr_b16 v[224:225], v22 offset:53248
  ds_read_b64_tr_b16 v[226:227], v22 offset:53760
L_ln_63:
  s_mov_b32 s56, s100
  s_mov_b32 s57, s101
  s_mov_b32 s58, 0xe00
  s_mov_b32 s59, 0x20000
  v_and_b32 v20, 3, v2
  v_mul_u32_u24 v23, 0x380, v3
  v_lshl_add_u32 v23, v20, 4, v23
  v_lshrrev_b32 v20, 2, v2
  v_lshl_add_u32 v23, v20, 1, v23
  s_lshr_b32 s9, s0, 1
  s_lshl_b32 s9, s9, 6
  s_and_b32 s11, s0, 1
  s_lshl_b32 s11, s11, 3
  s_add_u32 s9, s9, s11
  buffer_load_ushort v48, v23, s[56:59], s9 offen
  v_mov_b32 v20, 0x2490
  ds_read_b32 v49, v20
  s_lshl_b32 s12, s0, 14
  s_lshl_b32 s11, s4, 11
  s_add_u32 s12, s12, s11
  s_add_u32 s12, s12, 0x100000
  s_lshl_b32 s11, s4, 8
  v_and_b32 v21, 3, v2
  v_lshlrev_b32 v21, 4, v21
  v_lshl_add_u32 v21, v3, 6, v21
  v_add_u32 v21, s11, v21
  s_mov_b32 s13, 0x30d40
  s_nop 0
L_spin_66:
  buffer_load_dwordx4 v[24:27], v15, s[76:79], s12 offen sc1
  buffer_load_dwordx4 v[28:31], v15, s[76:79], s12 offen offset:1024 sc1
  s_waitcnt vmcnt(0)
  v_max3_u32 v16, v24, v25, v26
  v_max3_u32 v17, v27, v28, v29
  v_max3_u32 v16, v16, v30, v31
  v_max_u32 v16, v16, v17
  v_cmp_eq_u32 vcc, -1, v16
  s_nop 0
  s_cmp_eq_u64 vcc, 0
  s_cselect_b64 exec, -1, vcc
  s_nop 1
  s_cbranch_scc1 L_done_65
  s_sub_u32 s13, s13, 1
  s_cmp_lg_u32 s13, 0
  s_cbranch_scc1 L_spin_66
L_done_65:
  s_mov_b64 exec, -1
  v_add_f32 v24, v24, v28
  v_add_f32 v25, v25, v29
  v_add_f32 v26, v26, v30
  v_add_f32 v27, v27, v31
  v_add_f32_dpp v24, v24, v24 row_ror:4 row_mask:0xf bank_mask:0xf
  v_add_f32_dpp v25, v25, v25 row_ror:4 row_mask:0xf bank_mask:0xf
  v_add_f32_dpp v26, v26, v26 row_ror:4 row_mask:0xf bank_mask:0xf
  v_add_f32_dpp v27, v27, v27 row_ror:4 row_mask:0xf bank_mask:0xf
  v_add_f32_dpp v24, v24, v24 row_ror:8 row_mask:0xf bank_mask:0xf
  v_add_f32_dpp v25, v25, v25 row_ror:8 row_mask:0xf bank_mask:0xf
  v_add_f32_dpp v26, v26, v26 row_ror:8 row_mask:0xf bank_mask:0xf
  v_add_f32_dpp v27, v27, v27 row_ror:8 row_mask:0xf bank_mask:0xf
  ds_write_b128 v21, v[24:27] offset:9472
  v_lshlrev_b32 v20, 9, v3
  v_lshl_add_u32 v20, v2, 2, v20
  v_bfe_u32 v21, v2, 2, 1
  v_lshl_add_u32 v23, v21, 24, v23
  s_waitcnt lgkmcnt(0)
  s_barrier
  s_cmp_lg_u32 s4, 0
  s_cbranch_scc1 L_nw0_67
  ds_read_b32 v24, v20 offset:9472
  ds_read_b32 v25, v20 offset:9536
  ds_read_b32 v26, v20 offset:9600
  ds_read_b32 v27, v20 offset:9664
  ds_read_b32 v28, v20 offset:9728
  ds_read_b32 v29, v20 offset:9792
  ds_read_b32 v30, v20 offset:9856
  ds_read_b32 v31, v20 offset:9920
  v_lshlrev_b32 v48, 16, v48
  v_readfirstlane_b32 s11, v49
  s_waitcnt lgkmcnt(0)
  v_add_f32 v24, v24, v25
  v_add_f32 v26, v26, v27
  v_add_f32 v28, v28, v29
  v_add_f32 v30, v30, v31
  v_add_f32 v24, v24, v26
  v_add_f32 v28, v28, v30
  v_add_f32 v24, v24, v28
  v_cvt_pk_bf16_f32 v24, v24, v24
  v_and_b32 v24, 0xffff0000, v24
  v_add_f32 v24, v24, v48
  s_nop 1
  v_mov_b32_dpp v25, v24 row_ror:12 row_mask:0xf bank_mask:0xf
  v_cvt_pk_bf16_f32 v24, v24, v25
  v_min_u32 v24, -2, v24
  s_cmp_eq_u32 s11, 0
  s_nop 0
  s_cbranch_scc1 L_hs_68
  buffer_store_dword v24, v23, s[76:79], s9 offen
  s_branch L_b5_64
L_hs_68:
  buffer_store_dword v24, v23, s[76:79], s9 offen sc1
  s_branch L_b5_64
L_nw0_67:
  s_cmp_lt_u32 s4, 4
  s_cbranch_scc1 L_b5_64
  s_sub_u32 s11, s4, 4
  s_mul_i32 s12, s11, 0x380
  v_mov_b32 v21, 0x1000000
  v_cndmask_b32 v23, v21, v15, s[94:95]
  v_add_u32 v22, s12, v15
  s_mov_b32 s13, 0x30d40
  s_nop 0
L_spin_70:
  buffer_load_dwordx4 v[28:31], v23, s[76:79], s12 offen sc1
  s_waitcnt vmcnt(0)
  v_max3_u32 v16, v28, v29, v30
  v_max_u32 v16, v16, v31
  v_cmp_eq_u32 vcc, -1, v16
  s_nop 0
  s_cmp_eq_u64 vcc, 0
  s_nop 2
  s_cbranch_scc1 L_done_69
  s_sub_u32 s13, s13, 1
  s_cmp_lg_u32 s13, 0
  s_cbranch_scc1 L_spin_70
L_done_69:
  v_lshlrev_b32 v40, 16, v28
  v_and_b32 v41, 0xffff0000, v28
  v_lshlrev_b32 v42, 16, v29
  v_and_b32 v43, 0xffff0000, v29
  v_lshlrev_b32 v44, 16, v30
  v_and_b32 v45, 0xffff0000, v30
  v_lshlrev_b32 v46, 16, v31
  v_and_b32 v47, 0xffff0000, v31
  s_mov_b64 exec, s[94:95]
  ds_write_b128 v22, v[28:31] offset:4096
  s_mov_b64 exec, -1
  v_add_f32 v16, v40, v41
  v_add_f32 v17, v42, v43
  v_add_f32 v18, v44, v45
  v_add_f32 v19, v46, v47
  v_add_f32 v16, v16, v17
  v_add_f32 v18, v18, v19
  v_add_f32 v16, v16, v18
  s_nop 1
  v_add_f32_dpp v16, v16, v16 quad_perm:[1,0,3,2] row_mask:0xf bank_mask:0xf
  s_nop 1
  v_add_f32_dpp v16, v16, v16 quad_perm:[2,3,0,1] row_mask:0xf bank_mask:0xf
  s_nop 1
  v_add_f32_dpp v16, v16, v16 row_half_mirror row_mask:0xf bank_mask:0xf
  s_nop 1
  v_add_f32_dpp v16, v16, v16 row_mirror row_mask:0xf bank_mask:0xf
  s_nop 1
  v_add_f32_dpp v16, v16, v16 row_bcast:15 row_mask:0xa bank_mask:0xf
  s_nop 1
  v_add_f32_dpp v16, v16, v16 row_bcast:31 row_mask:0xc bank_mask:0xf
  s_nop 0
  v_readlane_b32 s98, v16, 63
  s_nop 1
  v_mov_b32 v16, s98
  v_mul_f32 v16, 0x3b124925, v16
  v_sub_f32 v17, v40, v16
  v_mul_f32 v18, v17, v17
  v_sub_f32 v17, v41, v16
  v_fmac_f32 v18, v17, v17
  v_sub_f32 v17, v42, v16
  v_fmac_f32 v18, v17, v17
  v_sub_f32 v17, v43, v16
  v_fmac_f32 v18, v17, v17
  v_sub_f32 v17, v44, v16
  v_fmac_f32 v18, v17, v17
  v_sub_f32 v17, v45, v16
  v_fmac_f32 v18, v17, v17
  v_sub_f32 v17, v46, v16
  v_fmac_f32 v18, v17, v17
  v_sub_f32 v17, v47, v16
  v_fmac_f32 v18, v17, v17
  v_cndmask_b32 v18, 0, v18, s[94:95]
  s_nop 1
  v_add_f32_dpp v18, v18, v18 quad_perm:[1,0,3,2] row_mask:0xf bank_mask:0xf
  s_nop 1
  v_add_f32_dpp v18, v18, v18 quad_perm:[2,3,0,1] row_mask:0xf bank_mask:0xf
  s_nop 1
  v_add_f32_dpp v18, v18, v18 row_half_mirror row_mask:0xf bank_mask:0xf
  s_nop 1
  v_add_f32_dpp v18, v18, v18 row_mirror row_mask:0xf bank_mask:0xf
  s_nop 1
  v_add_f32_dpp v18, v18, v18 row_bcast:15 row_mask:0xa bank_mask:0xf
  s_nop 1
  v_add_f32_dpp v18, v18, v18 row_bcast:31 row_mask:0xc bank_mask:0xf
  s_nop 0
  v_readlane_b32 s99, v18, 63
  v_cvt_pk_bf16_f32 v16, v16, v16
  v_and_b32 v16, 0xffff0000, v16
  v_mov_b32 v18, s99
  v_mul_f32 v18, 0x3b124925, v18
  v_cvt_pk_bf16_f32 v18, v18, v18
  v_and_b32 v18, 0xffff0000, v18
  v_add_f32 v18, 0x3727c5ac, v18
  v_cvt_pk_bf16_f32 v18, v18, v18
  v_and_b32 v18, 0xffff0000, v18
  v_sqrt_f32 v18, v18
  s_nop 0
  v_cvt_pk_bf16_f32 v18, v18, v18
  v_and_b32 v18, 0xffff0000, v18
  v_rcp_f32 v18, v18
  v_sub_f32 v40, v40, v16
  v_sub_f32 v41, v41, v16
  v_cvt_pk_bf16_f32 v17, v40, v41
  v_lshlrev_b32 v40, 16, v17
  v_and_b32 v41, 0xffff0000, v17
  v_mul_f32 v40, v40, v18
  v_mul_f32 v41, v41, v18
  v_sub_f32 v42, v42, v16
  v_sub_f32 v43, v43, v16
  v_cvt_pk_bf16_f32 v17, v42, v43
  v_lshlrev_b32 v42, 16, v17
  v_and_b32 v43, 0xffff0000, v17
  v_mul_f32 v42, v42, v18
  v_mul_f32 v43, v43, v18
  v_sub_f32 v44, v44, v16
  v_sub_f32 v45, v45, v16
  v_cvt_pk_bf16_f32 v17, v44, v45
  v_lshlrev_b32 v44, 16, v17
  v_and_b32 v45, 0xffff0000, v17
  v_mul_f32 v44, v44, v18
  v_mul_f32 v45, v45, v18
  v_sub_f32 v46, v46, v16
  v_sub_f32 v47, v47, v16
  v_cvt_pk_bf16_f32 v17, v46, v47
  v_lshlrev_b32 v46, 16, v17
  v_and_b32 v47, 0xffff0000, v17
  v_mul_f32 v46, v46, v18
  v_mul_f32 v47, v47, v18
  v_cvt_pk_bf16_f32 v24, v40, v41
  v_cvt_pk_bf16_f32 v25, v42, v43
  v_cvt_pk_bf16_f32 v26, v44, v45
  v_cvt_pk_bf16_f32 v27, v46, v47
  s_mov_b64 exec, s[94:95]
  ds_write_b128 v22, v[24:27]
  s_mov_b64 exec, -1
L_b5_64:
  s_waitcnt lgkmcnt(0)
  s_barrier
  s_cmp_ge_u32 s4, 4
  s_cbranch_scc1 L_b6_71
  v_and_b32 v22, 3, v1
  v_mul_u32_u24 v22, 0x380, v22
  v_lshl_add_u32 v22, v3, 4, v22
  ds_read_b128 v[116:119], v22
  ds_read_b128 v[120:123], v22 offset:64
  ds_read_b128 v[124:127], v22 offset:128
  ds_read_b128 v[128:131], v22 offset:192
  ds_read_b128 v[132:135], v22 offset:256
  ds_read_b128 v[136:139], v22 offset:320
  ds_read_b128 v[140:143], v22 offset:384
  ds_read_b128 v[144:147], v22 offset:448
  ds_read_b128 v[148:151], v22 offset:512
  ds_read_b128 v[152:155], v22 offset:576
  ds_read_b128 v[156:159], v22 offset:640
  ds_read_b128 v[160:163], v22 offset:704
  ds_read_b128 v[164:167], v22 offset:768
  ds_read_b128 v[168:171], v22 offset:832
  s_waitcnt lgkmcnt(13)
  v_mfma_f32_16x16x32_bf16 v[24:27], v[116:119], v[172:175], 0
  s_waitcnt lgkmcnt(12)
  v_mfma_f32_16x16x32_bf16 v[24:27], v[120:123], v[176:179], v[24:27]
  s_waitcnt lgkmcnt(11)
  v_mfma_f32_16x16x32_bf16 v[24:27], v[124:127], v[180:183], v[24:27]
  s_waitcnt lgkmcnt(10)
  v_mfma_f32_16x16x32_bf16 v[24:27], v[128:131], v[184:187], v[24:27]
  s_waitcnt lgkmcnt(9)
  v_mfma_f32_16x16x32_bf16 v[24:27], v[132:135], v[188:191], v[24:27]
  s_waitcnt lgkmcnt(8)
  v_mfma_f32_16x16x32_bf16 v[24:27], v[136:139], v[192:195], v[24:27]
  s_waitcnt lgkmcnt(7)
  v_mfma_f32_16x16x32_bf16 v[24:27], v[140:143], v[196:199], v[24:27]
  s_waitcnt lgkmcnt(6)
  v_mfma_f32_16x16x32_bf16 v[24:27], v[144:147], v[200:203], v[24:27]
  s_waitcnt lgkmcnt(5)
  v_mfma_f32_16x16x32_bf16 v[24:27], v[148:151], v[204:207], v[24:27]
  s_waitcnt lgkmcnt(4)
  v_mfma_f32_16x16x32_bf16 v[24:27], v[152:155], v[208:211], v[24:27]
  s_waitcnt lgkmcnt(3)
  v_mfma_f32_16x16x32_bf16 v[24:27], v[156:159], v[212:215], v[24:27]
  s_waitcnt lgkmcnt(2)
  v_mfma_f32_16x16x32_bf16 v[24:27], v[160:163], v[216:219], v[24:27]
  s_waitcnt lgkmcnt(1)
  v_mfma_f32_16x16x32_bf16 v[24:27], v[164:167], v[220:223], v[24:27]
  s_waitcnt lgkmcnt(0)
  v_mfma_f32_16x16x32_bf16 v[24:27], v[168:171], v[224:227], v[24:27]
  s_lshl_b32 s10, s4, 5
  v_lshlrev_b32 v22, 1, v2
  v_add_u32 v22, s10, v22
  s_mov_b32 s11, 0xbfb8aa3b
  s_nop 3
  v_cvt_pk_bf16_f32 v24, v24, v24
  v_and_b32 v24, 0xffff0000, v24
  v_cvt_pk_bf16_f32 v25, v25, v25
  v_and_b32 v25, 0xffff0000, v25
  v_cvt_pk_bf16_f32 v26, v26, v26
  v_and_b32 v26, 0xffff0000, v26
  v_cvt_pk_bf16_f32 v27, v27, v27
  v_and_b32 v27, 0xffff0000, v27
  v_mul_f32 v28, s11, v24
  v_mul_f32 v29, s11, v25
  v_mul_f32 v30, s11, v26
  v_mul_f32 v31, s11, v27
  v_exp_f32 v28, v28
  v_exp_f32 v29, v29
  v_exp_f32 v30, v30
  v_exp_f32 v31, v31
  v_add_f32 v28, 1.0, v28
  v_add_f32 v29, 1.0, v29
  v_add_f32 v30, 1.0, v30
  v_add_f32 v31, 1.0, v31
  v_rcp_f32 v28, v28
  v_rcp_f32 v29, v29
  v_rcp_f32 v30, v30
  v_rcp_f32 v31, v31
  v_mul_f32 v24, v24, v28
  v_mul_f32 v25, v25, v29
  v_mul_f32 v26, v26, v30
  v_mul_f32 v27, v27, v31
  v_cvt_pk_bf16_f32 v24, v24, v24
  ds_write_b16 v22, v24 offset:8192
  v_cvt_pk_bf16_f32 v25, v25, v25
  ds_write_b16 v22, v25 offset:8320
  v_cvt_pk_bf16_f32 v26, v26, v26
  ds_write_b16 v22, v26 offset:8448
  v_cvt_pk_bf16_f32 v27, v27, v27
  ds_write_b16 v22, v27 offset:8576
  s_nop 0
L_b6_71:
  s_waitcnt lgkmcnt(0)
  s_barrier
  s_cmp_ge_u32 s4, 7
  s_cbranch_scc1 L_fin_72
  v_and_b32 v22, 3, v1
  v_lshlrev_b32 v22, 7, v22
  v_lshl_add_u32 v22, v3, 4, v22
  ds_read_b128 v[116:119], v22 offset:8192
  ds_read_b128 v[120:123], v22 offset:8256
  v_mov_b32 v20, 0x2490
  ds_read_b32 v21, v20
  s_mul_i32 s10, s4, 0x7000
  s_lshl_b32 s11, s0, 8
  s_add_u32 s10, s10, s11
  s_add_u32 s10, s10, 0x8000
  s_waitcnt lgkmcnt(0)
  v_mfma_f32_16x16x32_bf16 v[24:27], v[116:119], v[84:87], 0
  v_mfma_f32_16x16x32_bf16 v[28:31], v[116:119], v[92:95], 0
  v_mfma_f32_16x16x32_bf16 v[32:35], v[116:119], v[100:103], 0
  v_mfma_f32_16x16x32_bf16 v[36:39], v[116:119], v[108:111], 0
  v_mfma_f32_16x16x32_bf16 v[24:27], v[120:123], v[88:91], v[24:27]
  v_mfma_f32_16x16x32_bf16 v[28:31], v[120:123], v[96:99], v[28:31]
  v_mfma_f32_16x16x32_bf16 v[32:35], v[120:123], v[104:107], v[32:35]
  v_mfma_f32_16x16x32_bf16 v[36:39], v[120:123], v[112:115], v[36:39]
  v_readfirstlane_b32 s11, v21
  s_mov_b64 exec, 0xffff
  s_cmp_eq_u32 s11, 0
  s_nop 4
  s_cbranch_scc1 L_slow_73
  v_min_u32 v24, -2, v24
  v_min_u32 v25, -2, v25
  v_min_u32 v26, -2, v26
  v_min_u32 v27, -2, v27
  buffer_store_dwordx4 v[24:27], v15, s[76:79], s10 offen
  s_add_u32 s10, s10, 0x1c00
  v_min_u32 v28, -2, v28
  v_min_u32 v29, -2, v29
  v_min_u32 v30, -2, v30
  v_min_u32 v31, -2, v31
  buffer_store_dwordx4 v[28:31], v15, s[76:79], s10 offen
  s_add_u32 s10, s10, 0x1c00
  v_min_u32 v32, -2, v32
  v_min_u32 v33, -2, v33
  v_min_u32 v34, -2, v34
  v_min_u32 v35, -2, v35
  buffer_store_dwordx4 v[32:35], v15, s[76:79], s10 offen
  s_add_u32 s10, s10, 0x1c00
  v_min_u32 v36, -2, v36
  v_min_u32 v37, -2, v37
  v_min_u32 v38, -2, v38
  v_min_u32 v39, -2, v39
  buffer_store_dwordx4 v[36:39], v15, s[76:79], s10 offen
  s_nop 1
  s_branch L_sd_74
L_slow_73:
  v_min_u32 v24, -2, v24
  v_min_u32 v25, -2, v25
  v_min_u32 v26, -2, v26
  v_min_u32 v27, -2, v27
  buffer_store_dwordx4 v[24:27], v15, s[76:79], s10 offen sc1
  s_add_u32 s10, s10, 0x1c00
  v_min_u32 v28, -2, v28
  v_min_u32 v29, -2, v29
  v_min_u32 v30, -2, v30
  v_min_u32 v31, -2, v31
  buffer_store_dwordx4 v[28:31], v15, s[76:79], s10 offen sc1
  s_add_u32 s10, s10, 0x1c00
  v_min_u32 v32, -2, v32
  v_min_u32 v33, -2, v33
  v_min_u32 v34, -2, v34
  v_min_u32 v35, -2, v35
  buffer_store_dwordx4 v[32:35], v15, s[76:79], s10 offen sc1
  s_add_u32 s10, s10, 0x1c00
  v_min_u32 v36, -2, v36
  v_min_u32 v37, -2, v37
  v_min_u32 v38, -2, v38
  v_min_u32 v39, -2, v39
  buffer_store_dwordx4 v[36:39], v15, s[76:79], s10 offen sc1
  s_nop 1
L_sd_74:
  s_or_b32 s10, s0, s4
  s_cmp_lg_u32 s10, 0
  s_cbranch_scc1 L_endp
  s_mov_b64 exec, 1
  v_mov_b32 v20, s32
  v_mov_b32 v21, 0
  s_mov_b32 s10, 0x6000
  buffer_store_dword v20, v21, s[76:79], s10 offen sc1
  s_branch L_endp
L_fin_72:
  v_mul_u32_u24 v22, 0x380, v3
  v_lshl_add_u32 v22, v2, 1, v22
  s_lshl_b32 s10, s0, 5
  v_add_u32 v22, s10, v22
  ds_read_u16 v23, v22 offset:4096
  s_mul_i32 s11, s0, 0x1c00
  s_add_u32 s11, s11, 0x8000
  s_add_u32 s12, s11, 0x1000
  s_mov_b32 s13, 0x30d40
L_spin_76:
  buffer_load_dwordx4 v[116:119], v15, s[76:79], s11 offen sc1
  buffer_load_dwordx4 v[120:123], v15, s[76:79], s11 offen offset:1024 sc1
  buffer_load_dwordx4 v[124:127], v15, s[76:79], s11 offen offset:2048 sc1
  buffer_load_dwordx4 v[128:131], v15, s[76:79], s11 offen offset:3072 sc1
  buffer_load_dwordx4 v[132:135], v15, s[76:79], s12 offen sc1
  buffer_load_dwordx4 v[136:139], v15, s[76:79], s12 offen offset:1024 sc1
  buffer_load_dwordx4 v[140:143], v15, s[76:79], s12 offen offset:2048 sc1
  s_waitcnt vmcnt(0)
  v_max3_u32 v16, v116, v117, v118
  v_max3_u32 v16, v16, v119, v120
  v_max3_u32 v16, v16, v121, v122
  v_max3_u32 v16, v16, v123, v124
  v_max3_u32 v16, v16, v125, v126
  v_max3_u32 v16, v16, v127, v128
  v_max3_u32 v16, v16, v129, v130
  v_max3_u32 v16, v16, v131, v132
  v_max3_u32 v16, v16, v133, v134
  v_max3_u32 v16, v16, v135, v136
  v_max3_u32 v16, v16, v137, v138
  v_max3_u32 v16, v16, v139, v140
  v_max3_u32 v16, v16, v141, v142
  v_max_u32 v16, v16, v143
  v_cmp_eq_u32_e64 s[100:101], -1, v16
  s_nop 0
  s_cmp_eq_u64 s[100:101], 0
  s_nop 2
  s_cbranch_scc1 L_done_75
  s_sub_u32 s13, s13, 1
  s_cmp_lg_u32 s13, 0
  s_cbranch_scc1 L_spin_76
L_done_75:
  v_add_f32 v116, v116, v120
  v_add_f32 v117, v117, v121
  v_add_f32 v118, v118, v122
  v_add_f32 v119, v119, v123
  v_add_f32 v116, v116, v124
  v_add_f32 v117, v117, v125
  v_add_f32 v118, v118, v126
  v_add_f32 v119, v119, v127
  v_add_f32 v116, v116, v128
  v_add_f32 v117, v117, v129
  v_add_f32 v118, v118, v130
  v_add_f32 v119, v119, v131
  v_add_f32 v116, v116, v132
  v_add_f32 v117, v117, v133
  v_add_f32 v118, v118, v134
  v_add_f32 v119, v119, v135
  v_add_f32 v116, v116, v136
  v_add_f32 v117, v117, v137
  v_add_f32 v118, v118, v138
  v_add_f32 v119, v119, v139
  v_add_f32 v116, v116, v140
  v_add_f32 v117, v117, v141
  v_add_f32 v118, v118, v142
  v_add_f32 v119, v119, v143
  v_mov_b32 v120, v116
  v_mov_b32 v121, v117
  v_mov_b32 v122, v118
  v_mov_b32 v123, v119
  v_permlane16_swap_b32 v116, v120
  v_permlane16_swap_b32 v117, v121
  v_permlane16_swap_b32 v118, v122
  v_permlane16_swap_b32 v119, v123
  v_add_f32 v116, v116, v120
  v_add_f32 v117, v117, v121
  v_add_f32 v118, v118, v122
  v_add_f32 v119, v119, v123
  v_mov_b32 v120, v116
  v_mov_b32 v121, v117
  v_mov_b32 v122, v118
  v_mov_b32 v123, v119
  v_permlane32_swap_b32 v116, v120
  v_permlane32_swap_b32 v117, v121
  v_permlane32_swap_b32 v118, v122
  v_permlane32_swap_b32 v119, v123
  v_add_f32 v116, v116, v120
  v_add_f32 v117, v117, v121
  v_add_f32 v118, v118, v122
  v_add_f32 v119, v119, v123
  v_cmp_eq_u32 vcc, 1, v3
  s_nop 1
  v_cndmask_b32 v116, v116, v117, vcc
  v_cmp_eq_u32 vcc, 2, v3
  s_nop 1
  v_cndmask_b32 v116, v116, v118, vcc
  v_cmp_eq_u32 vcc, 3, v3
  s_nop 1
  v_cndmask_b32 v116, v116, v119, vcc
  v_cvt_pk_bf16_f32 v116, v116, v116
  v_and_b32 v116, 0xffff0000, v116
  s_waitcnt lgkmcnt(0)
  v_lshlrev_b32 v23, 16, v23
  v_add_f32 v116, v116, v23
  v_cvt_pk_bf16_f32 v116, v116, v116
  buffer_store_short v116, v22, s[68:71], 0 offen
  s_nop 0
L_endp:
L_end:
  s_endpgm
.section .rodata,"a"
.p2align 6
.amdhsa_kernel sequential_preLN__mha_block_cached__dense_activation_silu__decode_kernel
  .amdhsa_next_free_vgpr 256
  .amdhsa_next_free_sgpr 102
  .amdhsa_accum_offset 256
  .amdhsa_group_segment_fixed_size 0
  .amdhsa_kernarg_size 88
  .amdhsa_user_sgpr_count 2
  .amdhsa_user_sgpr_kernarg_segment_ptr 1
  .amdhsa_system_sgpr_workgroup_id_x 1
  .amdhsa_float_denorm_mode_32 3
.end_amdhsa_kernel
```
